```python
import torch

def _softmax(x, axis=-1):
    return torch.softmax(x, dim=axis)
def _gelu(x):
    return torch.nn.functional.gelu(x, approximate="tanh")
def _silu(x):
    return torch.nn.functional.silu(x)
def _sigmoid(x):
    return torch.sigmoid(x)
def _layernorm(x, axis=-1, eps=1e-5):
    m = x.mean(dim=axis, keepdim=True)
    v = x.var(dim=axis, keepdim=True, unbiased=False)
    return (x - m) / torch.sqrt(v + eps)
def _scatter_add(tgt, idx, src, axis=0):
    return tgt.clone().index_add_(axis, idx, src)
def _segment_sum(src, seg, n):
    out = torch.zeros((n,) + src.shape[1:], dtype=src.dtype)
    return out.index_add_(0, seg, src)
def _pad(x, pw):
    flat = tuple(v for pair in reversed(pw) for v in pair)
    return torch.nn.functional.pad(x, flat)

kernel_name = 'recurrent_scan__grouped_kv_mqa__glu_gated_swiglu__prompt'

def setup_inputs():

    _w = (lambda a: (lambda t: t.to(torch.bfloat16) if t.is_floating_point() else t)(torch.as_tensor(a)))
    def _A_setup():
        B, S, D, H = 1, 2048, 512, 32
        Dh = D // H
        return {
            "x": _w((lambda *s: torch.randn(*s, dtype=torch.bfloat16) * 0.05)(B, S, D)),
            "wq": _w((lambda *s: torch.randn(*s, dtype=torch.bfloat16) * 0.2)(D, H * Dh)),
            "wk": _w((lambda *s: torch.randn(*s, dtype=torch.bfloat16) * 0.2)(D, Dh)),
            "wv": _w((lambda *s: torch.randn(*s, dtype=torch.bfloat16) * 0.2)(D, Dh)),
            "wo": _w((lambda *s: torch.randn(*s, dtype=torch.bfloat16) * 0.2)(H * Dh, D)),
        }
    _A_in = _A_setup()

    def _B_setup():
        B, S, D, F = 1, 2048, 512, 1376
        return {
            "x": _w((lambda *s: torch.randn(*s, dtype=torch.bfloat16) * 0.05)(B, S, D)),
            "w1": _w((lambda *s: torch.randn(*s, dtype=torch.bfloat16) * 0.1)(D, F) * (2.0 / D) ** 0.5),
            "w3": _w((lambda *s: torch.randn(*s, dtype=torch.bfloat16) * 0.1)(D, F) * (2.0 / D) ** 0.5),
            "w2": _w((lambda *s: torch.randn(*s, dtype=torch.bfloat16) * 0.1)(F, D) * (2.0 / F) ** 0.5),
        }
    _B_in = _B_setup()

    return {
        "A_x": _A_in["x"],
        "A_wq": _A_in["wq"],
        "A_wk": _A_in["wk"],
        "A_wv": _A_in["wv"],
        "A_wo": _A_in["wo"],
        "B_x": _B_in["x"],
        "B_w1": _B_in["w1"],
        "B_w3": _B_in["w3"],
        "B_w2": _B_in["w2"],
    }

def reference(A_x, A_wq, A_wk, A_wv, A_wo, B_x, B_w1, B_w3, B_w2):
    def _A_ref(x, wq, wk, wv, wo):
        B, S, D = x.shape
        H = 32
        Dh = D // H
        q = (lambda x, *d: x.permute(*d))((x @ wq).reshape(B, S, H, Dh), 0, 2, 1, 3)
        k = x @ wk
        v = x @ wv
        scores = torch.einsum("bhqd,bkd->bhqk", q, k) * (Dh ** -0.5)
        p = _softmax(scores, axis=-1)
        o = torch.einsum("bhqk,bkd->bhqd", p, v)
        return (lambda x, *d: x.permute(*d))(o, 0, 2, 1, 3).reshape(B, S, H * Dh) @ wo

    def _B_ref(x, w1, w3, w2):
        gate = torch.einsum("bsd,df->bsf", x, w1)
        up = torch.einsum("bsd,df->bsf", x, w3)
        h = _silu(gate) * up
        out = torch.einsum("bsf,fd->bsd", h, w2)
        return out

    x = A_x
    xn = _layernorm(x, axis=-1)
    s = _A_ref(xn, A_wq, A_wk, A_wv, A_wo)
    g = _silu(_B_ref(xn, B_w1, B_w3, B_w2))
    return x + s * g
```

```asm
; @launch grid=(512,1,1) block=(512,1,1) lds=81920
.amdgcn_target "amdgcn-amd-amdhsa--gfx950"
.text
.globl recurrent_scan__grouped_kv_mqa__glu_gated_swiglu__prompt_kernel
.p2align 8
.type recurrent_scan__grouped_kv_mqa__glu_gated_swiglu__prompt_kernel,@function
recurrent_scan__grouped_kv_mqa__glu_gated_swiglu__prompt_kernel:
  s_load_dwordx4 s[4:7], s[0:1], 0
  s_load_dwordx4 s[8:11], s[0:1], 48
  s_load_dwordx2 s[12:13], s[0:1], 64
  s_load_dwordx2 s[14:15], s[0:1], 88
  s_load_dwordx2 s[82:83], s[0:1], 80
  s_cmp_ge_u32 s2, 512
  s_cbranch_scc1 K_END
  s_and_b32 s35, s2, 255
  s_and_b32 s33, s35, 7
  s_lshr_b32 s34, s35, 3
  s_and_b32 s34, s34, 3
  s_lshl_b32 s34, s34, 3
  s_add_u32 s33, s33, s34
  s_lshr_b32 s34, s35, 5
  v_lshrrev_b32 v1, 6, v0
  v_and_b32 v0, 63, v0
  v_readfirstlane_b32 s32, v1
  v_lshlrev_b32 v1, 4, v0
  v_mov_b32 v127, 0
  v_mov_b32 v126, 0
  s_waitcnt lgkmcnt(0)
  s_mov_b32 s28, s14
  s_and_b32 s29, s15, 0xffff
  s_mov_b32 s30, 0x2a00000
  s_mov_b32 s31, 0x00020000
  s_cmp_lg_u32 s2, 0
  s_cbranch_scc1 K_NONCE
  s_cmp_lg_u32 s32, 0
  s_cbranch_scc1 K_NONCE
  s_memrealtime s[36:37]
  s_waitcnt lgkmcnt(0)
  s_or_b32 s36, s36, 1
  v_mov_b32 v2, 0
  v_mov_b32 v3, s36
  s_mov_b64 exec, 1
  global_store_dword v2, v3, s[82:83] sc1
  s_mov_b64 exec, -1
K_NONCE:
  s_sub_u32 s36, s2, 64
  s_cmp_lt_u32 s36, 256
  s_cbranch_scc1 K_ATT
  s_add_u32 s37, s2, 64
  s_sub_u32 s38, s2, 320
  s_cmp_lt_u32 s38, 64
  s_cselect_b32 s35, s38, s35
  s_cmp_lt_u32 s2, 64
  s_cselect_b32 s35, s37, s35
  s_cmp_ge_u32 s2, 64
  s_cbranch_scc1 F_START
  s_setprio 3
  s_sub_u32 s44, s35, 64
  s_load_dwordx4 s[20:23], s[0:1], 16
  v_lshrrev_b32 v2, 4, v0
  v_and_b32 v3, 15, v0
  v_lshlrev_b32 v4, 10, v2
  v_lshl_add_u32 v4, v3, 4, v4
  s_lshl_b32 s36, s44, 5
  s_lshl_b32 s37, s32, 2
  s_add_u32 s36, s36, s37
  s_lshl_b32 s36, s36, 10
  s_mov_b32 s16, s4
  s_and_b32 s17, s5, 0xffff
  s_mov_b32 s18, 0x200000
  s_mov_b32 s19, 0x00020000
  buffer_load_dwordx4 v[16:19], v4, s[16:19], s36 offen offset:0
  buffer_load_dwordx4 v[20:23], v4, s[16:19], s36 offen offset:256
  buffer_load_dwordx4 v[24:27], v4, s[16:19], s36 offen offset:512
  buffer_load_dwordx4 v[28:31], v4, s[16:19], s36 offen offset:768
  s_waitcnt lgkmcnt(0)
  s_cmp_lt_u32 s32, 4
  s_cselect_b32 s24, s20, s22
  s_cselect_b32 s25, s21, s23
  s_and_b32 s25, s25, 0xffff
  s_mov_b32 s26, 16384
  s_mov_b32 s27, 0x00020000
  s_and_b32 s36, s32, 3
  s_lshl_b32 s36, s36, 12
  s_lshl_b32 s37, s32, 12
  s_add_u32 s37, s37, 32768
  s_mov_b32 m0, s37
  s_nop 0
  buffer_load_dwordx4 v1, s[24:27], s36 offen lds
  s_add_u32 s36, s36, 1024
  s_add_u32 s37, s37, 1024
  s_mov_b32 m0, s37
  s_nop 0
  buffer_load_dwordx4 v1, s[24:27], s36 offen lds
  s_add_u32 s36, s36, 1024
  s_add_u32 s37, s37, 1024
  s_mov_b32 m0, s37
  s_nop 0
  buffer_load_dwordx4 v1, s[24:27], s36 offen lds
  s_add_u32 s36, s36, 1024
  s_add_u32 s37, s37, 1024
  s_mov_b32 m0, s37
  s_nop 0
  buffer_load_dwordx4 v1, s[24:27], s36 offen lds
  s_add_u32 s36, s36, 1024
  s_add_u32 s37, s37, 1024
  s_lshl_b32 s36, s32, 2
  v_add_u32 v12, s36, v2
  v_and_b32 v13, 15, v12
  v_xor_b32 v13, v13, v3
  v_lshlrev_b32 v13, 4, v13
  v_lshl_add_u32 v12, v12, 10, v13
  s_mov_b32 s40, 0x3f803f80
  s_mov_b32 s41, 0x00003f80
  s_mov_b32 s42, 0x3f800000
  v_mov_b32 v8, 0
  v_mov_b32 v9, 0
  v_mov_b32 v10, 0
  v_mov_b32 v11, 0
  s_waitcnt vmcnt(7)
  v_dot2_f32_bf16 v8, v16, s40, v8
  v_dot2_f32_bf16 v10, v16, v16, v10
  v_dot2_f32_bf16 v9, v17, s40, v9
  v_dot2_f32_bf16 v11, v17, v17, v11
  v_dot2_f32_bf16 v8, v18, s40, v8
  v_dot2_f32_bf16 v10, v18, v18, v10
  v_dot2_f32_bf16 v9, v19, s40, v9
  v_dot2_f32_bf16 v11, v19, v19, v11
  s_waitcnt vmcnt(6)
  v_dot2_f32_bf16 v8, v20, s40, v8
  v_dot2_f32_bf16 v10, v20, v20, v10
  v_dot2_f32_bf16 v9, v21, s40, v9
  v_dot2_f32_bf16 v11, v21, v21, v11
  v_dot2_f32_bf16 v8, v22, s40, v8
  v_dot2_f32_bf16 v10, v22, v22, v10
  v_dot2_f32_bf16 v9, v23, s40, v9
  v_dot2_f32_bf16 v11, v23, v23, v11
  s_waitcnt vmcnt(5)
  v_dot2_f32_bf16 v8, v24, s40, v8
  v_dot2_f32_bf16 v10, v24, v24, v10
  v_dot2_f32_bf16 v9, v25, s40, v9
  v_dot2_f32_bf16 v11, v25, v25, v11
  v_dot2_f32_bf16 v8, v26, s40, v8
  v_dot2_f32_bf16 v10, v26, v26, v10
  v_dot2_f32_bf16 v9, v27, s40, v9
  v_dot2_f32_bf16 v11, v27, v27, v11
  s_waitcnt vmcnt(4)
  v_dot2_f32_bf16 v8, v28, s40, v8
  v_dot2_f32_bf16 v10, v28, v28, v10
  v_dot2_f32_bf16 v9, v29, s40, v9
  v_dot2_f32_bf16 v11, v29, v29, v11
  v_dot2_f32_bf16 v8, v30, s40, v8
  v_dot2_f32_bf16 v10, v30, v30, v10
  v_dot2_f32_bf16 v9, v31, s40, v9
  v_dot2_f32_bf16 v11, v31, v31, v11
  s_nop 1
  v_add_f32 v8, v8, v9
  v_add_f32 v10, v10, v11
  s_nop 0
  v_add_f32_dpp v8, v8, v8 quad_perm:[1,0,3,2] row_mask:0xf bank_mask:0xf
  v_add_f32_dpp v10, v10, v10 quad_perm:[1,0,3,2] row_mask:0xf bank_mask:0xf
  s_nop 0
  v_add_f32_dpp v8, v8, v8 quad_perm:[2,3,0,1] row_mask:0xf bank_mask:0xf
  v_add_f32_dpp v10, v10, v10 quad_perm:[2,3,0,1] row_mask:0xf bank_mask:0xf
  s_nop 0
  v_add_f32_dpp v8, v8, v8 row_half_mirror row_mask:0xf bank_mask:0xf
  v_add_f32_dpp v10, v10, v10 row_half_mirror row_mask:0xf bank_mask:0xf
  s_nop 0
  v_add_f32_dpp v8, v8, v8 row_mirror row_mask:0xf bank_mask:0xf
  v_add_f32_dpp v10, v10, v10 row_mirror row_mask:0xf bank_mask:0xf
  v_mul_f32 v8, 0x3b000000, v8
  v_mul_f32 v10, 0x3b000000, v10
  v_fma_f32 v10, -v8, v8, v10
  v_max_f32 v10, 0, v10
  v_cvt_pk_bf16_f32 v9, v8, v10
  v_lshlrev_b32 v8, 16, v9
  v_and_b32 v10, 0xffff0000, v9
  v_add_f32 v10, 0x3727c5ac, v10
  v_cvt_pk_bf16_f32 v10, v10, v10
  v_lshlrev_b32 v10, 16, v10
  v_sqrt_f32 v10, v10
  s_nop 0
  v_cvt_pk_bf16_f32 v10, v10, v10
  v_lshlrev_b32 v10, 16, v10
  v_rcp_f32 v10, v10
  v_sub_f32 v8, 0, v8
  v_mov_b32 v11, v10
  v_dot2_f32_bf16 v48, v16, s41, v8
  v_dot2_f32_bf16 v49, v16, s42, v8
  v_dot2_f32_bf16 v52, v17, s41, v8
  v_dot2_f32_bf16 v53, v17, s42, v8
  s_nop 0
  v_cvt_pk_bf16_f32 v50, v48, v49
  v_dot2_f32_bf16 v56, v18, s41, v8
  v_dot2_f32_bf16 v57, v18, s42, v8
  v_cvt_pk_bf16_f32 v54, v52, v53
  v_lshlrev_b32 v48, 16, v50
  v_and_b32 v49, 0xffff0000, v50
  v_dot2_f32_bf16 v60, v19, s41, v8
  v_dot2_f32_bf16 v61, v19, s42, v8
  v_cvt_pk_bf16_f32 v58, v56, v57
  v_lshlrev_b32 v52, 16, v54
  v_and_b32 v53, 0xffff0000, v54
  v_pk_mul_f32 v[48:49], v[48:49], v[10:11]
  v_cvt_pk_bf16_f32 v16, v48, v49
  v_dot2_f32_bf16 v48, v20, s41, v8
  v_dot2_f32_bf16 v49, v20, s42, v8
  v_cvt_pk_bf16_f32 v62, v60, v61
  v_lshlrev_b32 v56, 16, v58
  v_and_b32 v57, 0xffff0000, v58
  v_pk_mul_f32 v[52:53], v[52:53], v[10:11]
  v_cvt_pk_bf16_f32 v17, v52, v53
  v_dot2_f32_bf16 v52, v21, s41, v8
  v_dot2_f32_bf16 v53, v21, s42, v8
  v_cvt_pk_bf16_f32 v50, v48, v49
  v_lshlrev_b32 v60, 16, v62
  v_and_b32 v61, 0xffff0000, v62
  v_pk_mul_f32 v[56:57], v[56:57], v[10:11]
  v_cvt_pk_bf16_f32 v18, v56, v57
  v_dot2_f32_bf16 v56, v22, s41, v8
  v_dot2_f32_bf16 v57, v22, s42, v8
  v_cvt_pk_bf16_f32 v54, v52, v53
  v_lshlrev_b32 v48, 16, v50
  v_and_b32 v49, 0xffff0000, v50
  v_pk_mul_f32 v[60:61], v[60:61], v[10:11]
  v_cvt_pk_bf16_f32 v19, v60, v61
  ds_write_b128 v12, v[16:19] offset:0
  v_dot2_f32_bf16 v60, v23, s41, v8
  v_dot2_f32_bf16 v61, v23, s42, v8
  v_cvt_pk_bf16_f32 v58, v56, v57
  v_lshlrev_b32 v52, 16, v54
  v_and_b32 v53, 0xffff0000, v54
  v_pk_mul_f32 v[48:49], v[48:49], v[10:11]
  v_cvt_pk_bf16_f32 v20, v48, v49
  v_dot2_f32_bf16 v48, v24, s41, v8
  v_dot2_f32_bf16 v49, v24, s42, v8
  v_cvt_pk_bf16_f32 v62, v60, v61
  v_lshlrev_b32 v56, 16, v58
  v_and_b32 v57, 0xffff0000, v58
  v_pk_mul_f32 v[52:53], v[52:53], v[10:11]
  v_cvt_pk_bf16_f32 v21, v52, v53
  v_dot2_f32_bf16 v52, v25, s41, v8
  v_dot2_f32_bf16 v53, v25, s42, v8
  v_cvt_pk_bf16_f32 v50, v48, v49
  v_lshlrev_b32 v60, 16, v62
  v_and_b32 v61, 0xffff0000, v62
  v_pk_mul_f32 v[56:57], v[56:57], v[10:11]
  v_cvt_pk_bf16_f32 v22, v56, v57
  v_dot2_f32_bf16 v56, v26, s41, v8
  v_dot2_f32_bf16 v57, v26, s42, v8
  v_cvt_pk_bf16_f32 v54, v52, v53
  v_lshlrev_b32 v48, 16, v50
  v_and_b32 v49, 0xffff0000, v50
  v_pk_mul_f32 v[60:61], v[60:61], v[10:11]
  v_cvt_pk_bf16_f32 v23, v60, v61
  ds_write_b128 v12, v[20:23] offset:256
  v_dot2_f32_bf16 v60, v27, s41, v8
  v_dot2_f32_bf16 v61, v27, s42, v8
  v_cvt_pk_bf16_f32 v58, v56, v57
  v_lshlrev_b32 v52, 16, v54
  v_and_b32 v53, 0xffff0000, v54
  v_pk_mul_f32 v[48:49], v[48:49], v[10:11]
  v_cvt_pk_bf16_f32 v24, v48, v49
  v_dot2_f32_bf16 v48, v28, s41, v8
  v_dot2_f32_bf16 v49, v28, s42, v8
  v_cvt_pk_bf16_f32 v62, v60, v61
  v_lshlrev_b32 v56, 16, v58
  v_and_b32 v57, 0xffff0000, v58
  v_pk_mul_f32 v[52:53], v[52:53], v[10:11]
  v_cvt_pk_bf16_f32 v25, v52, v53
  v_dot2_f32_bf16 v52, v29, s41, v8
  v_dot2_f32_bf16 v53, v29, s42, v8
  v_cvt_pk_bf16_f32 v50, v48, v49
  v_lshlrev_b32 v60, 16, v62
  v_and_b32 v61, 0xffff0000, v62
  v_pk_mul_f32 v[56:57], v[56:57], v[10:11]
  v_cvt_pk_bf16_f32 v26, v56, v57
  v_dot2_f32_bf16 v56, v30, s41, v8
  v_dot2_f32_bf16 v57, v30, s42, v8
  v_cvt_pk_bf16_f32 v54, v52, v53
  v_lshlrev_b32 v48, 16, v50
  v_and_b32 v49, 0xffff0000, v50
  v_pk_mul_f32 v[60:61], v[60:61], v[10:11]
  v_cvt_pk_bf16_f32 v27, v60, v61
  ds_write_b128 v12, v[24:27] offset:512
  v_dot2_f32_bf16 v60, v31, s41, v8
  v_dot2_f32_bf16 v61, v31, s42, v8
  v_cvt_pk_bf16_f32 v58, v56, v57
  v_lshlrev_b32 v52, 16, v54
  v_and_b32 v53, 0xffff0000, v54
  v_pk_mul_f32 v[48:49], v[48:49], v[10:11]
  v_cvt_pk_bf16_f32 v28, v48, v49
  v_cvt_pk_bf16_f32 v62, v60, v61
  v_lshlrev_b32 v56, 16, v58
  v_and_b32 v57, 0xffff0000, v58
  v_pk_mul_f32 v[52:53], v[52:53], v[10:11]
  v_cvt_pk_bf16_f32 v29, v52, v53
  v_lshlrev_b32 v60, 16, v62
  v_and_b32 v61, 0xffff0000, v62
  v_pk_mul_f32 v[56:57], v[56:57], v[10:11]
  v_cvt_pk_bf16_f32 v30, v56, v57
  v_pk_mul_f32 v[60:61], v[60:61], v[10:11]
  v_cvt_pk_bf16_f32 v31, v60, v61
  ds_write_b128 v12, v[28:31] offset:768
  s_cmp_lg_u32 s32, 0
  s_cbranch_scc1 F_KNE
  global_load_dword v126, v127, s[82:83] sc1
F_KNE:
  v_and_b32 v2, 31, v0
  v_lshrrev_b32 v3, 5, v0
  v_and_b32 v4, 15, v0
  v_xor_b32 v4, v4, v3
  v_lshlrev_b32 v4, 4, v4
  v_lshl_add_u32 v4, v2, 10, v4
  s_lshr_b32 s45, s32, 2
  s_and_b32 s47, s32, 3
  s_lshl_b32 s37, s47, 8
  v_add_u32 v14, s37, v4
  v_bfe_u32 v9, v0, 2, 2
  v_and_b32 v10, 3, v0
  v_lshl_add_u32 v15, v3, 3, v9
  v_lshlrev_b32 v15, 5, v15
  v_lshl_add_u32 v15, v10, 3, v15
  s_lshl_b32 s36, s32, 12
  s_add_u32 s36, s36, 32768
  v_add_u32 v15, s36, v15
  v_xor_b32 v48, 0, v14
  v_xor_b32 v49, 32, v14
  v_xor_b32 v50, 64, v14
  v_xor_b32 v51, 96, v14
  v_xor_b32 v52, 128, v14
  v_xor_b32 v53, 160, v14
  v_xor_b32 v54, 192, v14
  v_xor_b32 v55, 224, v14
  s_waitcnt vmcnt(0) lgkmcnt(0)
  s_barrier
  ds_read_b64_tr_b16 v[56:57], v15 offset:0
  ds_read_b64_tr_b16 v[58:59], v15 offset:128
  ds_read_b128 v[60:63], v48
  ds_read_b64_tr_b16 v[64:65], v15 offset:512
  ds_read_b64_tr_b16 v[66:67], v15 offset:640
  ds_read_b128 v[68:71], v49
  ds_read_b64_tr_b16 v[72:73], v15 offset:1024
  ds_read_b64_tr_b16 v[74:75], v15 offset:1152
  ds_read_b128 v[76:79], v50
  ds_read_b64_tr_b16 v[80:81], v15 offset:1536
  ds_read_b64_tr_b16 v[82:83], v15 offset:1664
  ds_read_b128 v[84:87], v51
  ds_read_b64_tr_b16 v[88:89], v15 offset:2048
  ds_read_b64_tr_b16 v[90:91], v15 offset:2176
  ds_read_b128 v[92:95], v52
  ds_read_b64_tr_b16 v[96:97], v15 offset:2560
  ds_read_b64_tr_b16 v[98:99], v15 offset:2688
  ds_read_b128 v[100:103], v53
  ds_read_b64_tr_b16 v[104:105], v15 offset:3072
  ds_read_b64_tr_b16 v[106:107], v15 offset:3200
  ds_read_b128 v[108:111], v54
  ds_read_b64_tr_b16 v[112:113], v15 offset:3584
  ds_read_b64_tr_b16 v[114:115], v15 offset:3712
  ds_read_b128 v[116:119], v55
  s_cmp_eq_u32 s45, 1
  s_cbranch_scc1 F_KVV
  s_waitcnt lgkmcnt(15)
  v_mfma_f32_32x32x16_bf16 v[16:31], v[56:59], v[60:63], 0
  v_mfma_f32_32x32x16_bf16 v[16:31], v[64:67], v[68:71], v[16:31]
  v_mfma_f32_32x32x16_bf16 v[16:31], v[72:75], v[76:79], v[16:31]
  s_waitcnt lgkmcnt(12)
  v_mfma_f32_32x32x16_bf16 v[16:31], v[80:83], v[84:87], v[16:31]
  s_waitcnt lgkmcnt(9)
  v_mfma_f32_32x32x16_bf16 v[16:31], v[88:91], v[92:95], v[16:31]
  s_waitcnt lgkmcnt(6)
  v_mfma_f32_32x32x16_bf16 v[16:31], v[96:99], v[100:103], v[16:31]
  s_waitcnt lgkmcnt(3)
  v_mfma_f32_32x32x16_bf16 v[16:31], v[104:107], v[108:111], v[16:31]
  s_waitcnt lgkmcnt(0)
  v_mfma_f32_32x32x16_bf16 v[16:31], v[112:115], v[116:119], v[16:31]
  s_branch F_KVR
F_KVV:
  s_waitcnt lgkmcnt(15)
  v_mfma_f32_32x32x16_bf16 v[16:31], v[60:63], v[56:59], 0
  v_mfma_f32_32x32x16_bf16 v[16:31], v[68:71], v[64:67], v[16:31]
  v_mfma_f32_32x32x16_bf16 v[16:31], v[76:79], v[72:75], v[16:31]
  s_waitcnt lgkmcnt(12)
  v_mfma_f32_32x32x16_bf16 v[16:31], v[84:87], v[80:83], v[16:31]
  s_waitcnt lgkmcnt(9)
  v_mfma_f32_32x32x16_bf16 v[16:31], v[92:95], v[88:91], v[16:31]
  s_waitcnt lgkmcnt(6)
  v_mfma_f32_32x32x16_bf16 v[16:31], v[100:103], v[96:99], v[16:31]
  s_waitcnt lgkmcnt(3)
  v_mfma_f32_32x32x16_bf16 v[16:31], v[108:111], v[104:107], v[16:31]
  s_waitcnt lgkmcnt(0)
  v_mfma_f32_32x32x16_bf16 v[16:31], v[116:119], v[112:115], v[16:31]
F_KVR:
  s_lshl_b32 s36, s32, 12
  s_add_u32 s36, s36, 32768
  v_add_u32 v12, s36, v1
  s_nop 8
  ds_write_b128 v12, v[16:19] offset:0
  ds_write_b128 v12, v[20:23] offset:1024
  ds_write_b128 v12, v[24:27] offset:2048
  ds_write_b128 v12, v[28:31] offset:3072
  s_lshl_b32 s36, s45, 14
  s_and_b32 s37, s32, 1
  s_lshl_b32 s37, s37, 11
  s_add_u32 s36, s36, s37
  s_add_u32 s36, s36, 32768
  v_add_u32 v13, s36, v1
  s_waitcnt lgkmcnt(0)
  s_barrier
  s_cmp_eq_u32 s32, 0
  s_cbranch_scc1 F_KVS
  s_bfe_u32 s36, s32, 0x20001
  s_cmp_lg_u32 s36, 2
  s_cbranch_scc1 F_KVD
F_KVS:
  ds_read_b128 v[56:59], v13 offset:0
  ds_read_b128 v[60:63], v13 offset:1024
  ds_read_b128 v[64:67], v13 offset:4096
  ds_read_b128 v[68:71], v13 offset:5120
  ds_read_b128 v[72:75], v13 offset:8192
  ds_read_b128 v[76:79], v13 offset:9216
  ds_read_b128 v[80:83], v13 offset:12288
  ds_read_b128 v[84:87], v13 offset:13312
  s_waitcnt lgkmcnt(5)
  v_add_f32 v56, v56, v64
  v_add_f32 v57, v57, v65
  v_add_f32 v58, v58, v66
  v_add_f32 v59, v59, v67
  s_waitcnt lgkmcnt(4)
  v_add_f32 v60, v60, v68
  v_add_f32 v61, v61, v69
  v_add_f32 v62, v62, v70
  v_add_f32 v63, v63, v71
  s_waitcnt lgkmcnt(3)
  v_add_f32 v56, v56, v72
  v_add_f32 v57, v57, v73
  v_add_f32 v58, v58, v74
  v_add_f32 v59, v59, v75
  s_waitcnt lgkmcnt(2)
  v_add_f32 v60, v60, v76
  v_add_f32 v61, v61, v77
  v_add_f32 v62, v62, v78
  v_add_f32 v63, v63, v79
  s_waitcnt lgkmcnt(1)
  v_add_f32 v56, v56, v80
  v_add_f32 v57, v57, v81
  v_add_f32 v58, v58, v82
  v_add_f32 v59, v59, v83
  s_waitcnt lgkmcnt(0)
  v_add_f32 v60, v60, v84
  v_add_f32 v61, v61, v85
  v_add_f32 v62, v62, v86
  v_add_f32 v63, v63, v87
  v_cvt_pk_bf16_f32 v32, v56, v57
  v_cvt_pk_bf16_f32 v33, v58, v59
  v_cvt_pk_bf16_f32 v34, v60, v61
  v_cvt_pk_bf16_f32 v35, v62, v63
  s_lshl_b32 s38, s44, 11
  s_add_u32 s38, s38, 4194304
  s_cmp_eq_u32 s45, 1
  s_cbranch_scc1 F_KVSV
  buffer_store_dwordx4 v[32:35], v1, s[28:31], s38 offen sc1
  s_branch F_KVD
F_KVSV:
  v_and_b32 v12, 15, v0
  v_lshlrev_b32 v12, 4, v12
  v_lshl_add_u32 v12, v3, 8, v12
  s_and_b32 s36, s32, 1
  s_lshl_b32 s36, s36, 9
  s_add_u32 s38, s38, s36
  s_mov_b32 exec_lo, 0xffff
  s_mov_b32 exec_hi, 0xffff
  buffer_store_dwordx4 v[32:35], v12, s[28:31], s38 offen offset:1024 sc1
  s_mov_b64 exec, -1
F_KVD:
  s_waitcnt vmcnt(0)
  s_barrier
  s_cmp_lg_u32 s32, 0
  s_cbranch_scc1 F_KVE
  s_mov_b32 s39, 65536
  s_waitcnt vmcnt(0)
NON1:
  v_readfirstlane_b32 s80, v126
  s_cmp_lg_u32 s80, 0
  s_cbranch_scc1 NON1_OK
  s_sleep 1
  global_load_dword v126, v127, s[82:83] sc1
  s_waitcnt vmcnt(0)
  s_sub_u32 s39, s39, 1
  s_cmp_lg_u32 s39, 0
  s_cbranch_scc1 NON1
NON1_OK:
  s_lshl_b32 s36, s44, 2
  s_add_u32 s36, s36, 0xf00000
  v_lshlrev_b32 v12, 8, v0
  v_add_u32 v12, s36, v12
  v_mov_b32 v13, s80
  s_mov_b64 exec, 0xff
  global_store_dword v12, v13, s[14:15] sc1
  s_mov_b64 exec, -1
F_KVE:
  s_setprio 0
  s_barrier
  s_branch F_START
K_ATT:
  v_lshrrev_b32 v2, 3, v0
  v_and_b32 v3, 7, v0
  v_lshlrev_b32 v4, 10, v2
  v_lshl_add_u32 v4, v3, 4, v4
  s_lshl_b32 s44, s33, 6
  s_lshl_b32 s37, s32, 3
  s_add_u32 s44, s44, s37
  s_lshl_b32 s44, s44, 10
  s_mov_b32 s16, s4
  s_and_b32 s17, s5, 0xffff
  s_mov_b32 s18, 0x200000
  s_mov_b32 s19, 0x00020000
  buffer_load_dwordx4 v[16:19], v4, s[16:19], s44 offen offset:0
  buffer_load_dwordx4 v[20:23], v4, s[16:19], s44 offen offset:128
  buffer_load_dwordx4 v[24:27], v4, s[16:19], s44 offen offset:256
  buffer_load_dwordx4 v[28:31], v4, s[16:19], s44 offen offset:384
  s_mov_b32 s20, s6
  s_and_b32 s21, s7, 0xffff
  s_mov_b32 s22, 0x80000
  s_mov_b32 s23, 0x00020000
  v_bfe_u32 v5, v2, 1, 1
  v_lshlrev_b32 v5, 2, v5
  v_xor_b32 v5, v5, v3
  v_lshlrev_b32 v5, 4, v5
  v_lshl_add_u32 v5, v2, 10, v5
  s_lshl_b32 s36, s32, 16
  s_lshl_b32 s37, s34, 7
  s_add_u32 s36, s36, s37
  s_lshl_b32 s37, s32, 13
  s_mov_b32 m0, s37
  s_nop 0
  buffer_load_dwordx4 v5, s[20:23], s36 offen lds
  s_add_u32 s36, s36, 8192
  s_add_u32 s37, s37, 1024
  buffer_load_dwordx4 v[32:35], v4, s[16:19], s44 offen offset:512
  s_mov_b32 m0, s37
  s_nop 0
  buffer_load_dwordx4 v5, s[20:23], s36 offen lds
  s_add_u32 s36, s36, 8192
  s_add_u32 s37, s37, 1024
  buffer_load_dwordx4 v[36:39], v4, s[16:19], s44 offen offset:640
  s_mov_b32 m0, s37
  s_nop 0
  buffer_load_dwordx4 v5, s[20:23], s36 offen lds
  s_add_u32 s36, s36, 8192
  s_add_u32 s37, s37, 1024
  buffer_load_dwordx4 v[40:43], v4, s[16:19], s44 offen offset:768
  s_mov_b32 m0, s37
  s_nop 0
  buffer_load_dwordx4 v5, s[20:23], s36 offen lds
  s_add_u32 s36, s36, 8192
  s_add_u32 s37, s37, 1024
  buffer_load_dwordx4 v[44:47], v4, s[16:19], s44 offen offset:896
  s_mov_b32 m0, s37
  s_nop 0
  buffer_load_dwordx4 v5, s[20:23], s36 offen lds
  s_add_u32 s36, s36, 8192
  s_add_u32 s37, s37, 1024
  s_mov_b32 m0, s37
  s_nop 0
  buffer_load_dwordx4 v5, s[20:23], s36 offen lds
  s_add_u32 s36, s36, 8192
  s_add_u32 s37, s37, 1024
  s_mov_b32 m0, s37
  s_nop 0
  buffer_load_dwordx4 v5, s[20:23], s36 offen lds
  s_add_u32 s36, s36, 8192
  s_add_u32 s37, s37, 1024
  s_mov_b32 m0, s37
  s_nop 0
  buffer_load_dwordx4 v5, s[20:23], s36 offen lds
  s_add_u32 s36, s36, 8192
  s_add_u32 s37, s37, 1024
  s_and_b32 s36, s32, 1
  s_lshl_b32 s36, s36, 7
  s_lshl_b32 s37, s32, 13
  s_add_u32 s36, s36, s37
  v_xor_b32 v12, v2, v3
  v_lshlrev_b32 v12, 4, v12
  v_lshl_add_u32 v12, v2, 10, v12
  v_add_u32 v12, s36, v12
  v_xor_b32 v13, 128, v12
  s_mov_b32 s40, 0x3f803f80
  s_mov_b32 s41, 0x00003f80
  s_mov_b32 s42, 0x3f800000
  v_mov_b32 v8, 0
  v_mov_b32 v9, 0
  v_mov_b32 v10, 0
  v_mov_b32 v11, 0
  s_waitcnt vmcnt(15)
  v_dot2_f32_bf16 v8, v16, s40, v8
  v_dot2_f32_bf16 v10, v16, v16, v10
  v_dot2_f32_bf16 v9, v17, s40, v9
  v_dot2_f32_bf16 v11, v17, v17, v11
  v_dot2_f32_bf16 v8, v18, s40, v8
  v_dot2_f32_bf16 v10, v18, v18, v10
  v_dot2_f32_bf16 v9, v19, s40, v9
  v_dot2_f32_bf16 v11, v19, v19, v11
  s_waitcnt vmcnt(14)
  v_dot2_f32_bf16 v8, v20, s40, v8
  v_dot2_f32_bf16 v10, v20, v20, v10
  v_dot2_f32_bf16 v9, v21, s40, v9
  v_dot2_f32_bf16 v11, v21, v21, v11
  v_dot2_f32_bf16 v8, v22, s40, v8
  v_dot2_f32_bf16 v10, v22, v22, v10
  v_dot2_f32_bf16 v9, v23, s40, v9
  v_dot2_f32_bf16 v11, v23, v23, v11
  s_waitcnt vmcnt(13)
  v_dot2_f32_bf16 v8, v24, s40, v8
  v_dot2_f32_bf16 v10, v24, v24, v10
  v_dot2_f32_bf16 v9, v25, s40, v9
  v_dot2_f32_bf16 v11, v25, v25, v11
  v_dot2_f32_bf16 v8, v26, s40, v8
  v_dot2_f32_bf16 v10, v26, v26, v10
  v_dot2_f32_bf16 v9, v27, s40, v9
  v_dot2_f32_bf16 v11, v27, v27, v11
  s_waitcnt vmcnt(12)
  v_dot2_f32_bf16 v8, v28, s40, v8
  v_dot2_f32_bf16 v10, v28, v28, v10
  v_dot2_f32_bf16 v9, v29, s40, v9
  v_dot2_f32_bf16 v11, v29, v29, v11
  v_dot2_f32_bf16 v8, v30, s40, v8
  v_dot2_f32_bf16 v10, v30, v30, v10
  v_dot2_f32_bf16 v9, v31, s40, v9
  v_dot2_f32_bf16 v11, v31, v31, v11
  s_waitcnt vmcnt(10)
  v_dot2_f32_bf16 v8, v32, s40, v8
  v_dot2_f32_bf16 v10, v32, v32, v10
  v_dot2_f32_bf16 v9, v33, s40, v9
  v_dot2_f32_bf16 v11, v33, v33, v11
  v_dot2_f32_bf16 v8, v34, s40, v8
  v_dot2_f32_bf16 v10, v34, v34, v10
  v_dot2_f32_bf16 v9, v35, s40, v9
  v_dot2_f32_bf16 v11, v35, v35, v11
  s_waitcnt vmcnt(8)
  v_dot2_f32_bf16 v8, v36, s40, v8
  v_dot2_f32_bf16 v10, v36, v36, v10
  v_dot2_f32_bf16 v9, v37, s40, v9
  v_dot2_f32_bf16 v11, v37, v37, v11
  v_dot2_f32_bf16 v8, v38, s40, v8
  v_dot2_f32_bf16 v10, v38, v38, v10
  v_dot2_f32_bf16 v9, v39, s40, v9
  v_dot2_f32_bf16 v11, v39, v39, v11
  s_waitcnt vmcnt(6)
  v_dot2_f32_bf16 v8, v40, s40, v8
  v_dot2_f32_bf16 v10, v40, v40, v10
  v_dot2_f32_bf16 v9, v41, s40, v9
  v_dot2_f32_bf16 v11, v41, v41, v11
  v_dot2_f32_bf16 v8, v42, s40, v8
  v_dot2_f32_bf16 v10, v42, v42, v10
  v_dot2_f32_bf16 v9, v43, s40, v9
  v_dot2_f32_bf16 v11, v43, v43, v11
  s_waitcnt vmcnt(4)
  v_dot2_f32_bf16 v8, v44, s40, v8
  v_dot2_f32_bf16 v10, v44, v44, v10
  v_dot2_f32_bf16 v9, v45, s40, v9
  v_dot2_f32_bf16 v11, v45, v45, v11
  v_dot2_f32_bf16 v8, v46, s40, v8
  v_dot2_f32_bf16 v10, v46, v46, v10
  v_dot2_f32_bf16 v9, v47, s40, v9
  v_dot2_f32_bf16 v11, v47, v47, v11
  s_nop 1
  v_add_f32 v8, v8, v9
  v_add_f32 v10, v10, v11
  s_nop 0
  v_add_f32_dpp v8, v8, v8 quad_perm:[1,0,3,2] row_mask:0xf bank_mask:0xf
  v_add_f32_dpp v10, v10, v10 quad_perm:[1,0,3,2] row_mask:0xf bank_mask:0xf
  s_nop 0
  v_add_f32_dpp v8, v8, v8 quad_perm:[2,3,0,1] row_mask:0xf bank_mask:0xf
  v_add_f32_dpp v10, v10, v10 quad_perm:[2,3,0,1] row_mask:0xf bank_mask:0xf
  s_nop 0
  v_add_f32_dpp v8, v8, v8 row_half_mirror row_mask:0xf bank_mask:0xf
  v_add_f32_dpp v10, v10, v10 row_half_mirror row_mask:0xf bank_mask:0xf
  v_mul_f32 v8, 0x3b000000, v8
  v_mul_f32 v10, 0x3b000000, v10
  v_fma_f32 v10, -v8, v8, v10
  v_max_f32 v10, 0, v10
  v_cvt_pk_bf16_f32 v9, v8, v10
  v_lshlrev_b32 v8, 16, v9
  v_and_b32 v10, 0xffff0000, v9
  v_add_f32 v10, 0x3727c5ac, v10
  v_cvt_pk_bf16_f32 v10, v10, v10
  v_lshlrev_b32 v10, 16, v10
  v_sqrt_f32 v10, v10
  s_nop 0
  v_cvt_pk_bf16_f32 v10, v10, v10
  v_lshlrev_b32 v10, 16, v10
  v_rcp_f32 v10, v10
  v_sub_f32 v8, 0, v8
  v_mov_b32 v11, v10
  v_dot2_f32_bf16 v48, v16, s41, v8
  v_dot2_f32_bf16 v49, v16, s42, v8
  v_dot2_f32_bf16 v52, v17, s41, v8
  v_dot2_f32_bf16 v53, v17, s42, v8
  s_nop 0
  v_cvt_pk_bf16_f32 v50, v48, v49
  v_dot2_f32_bf16 v56, v18, s41, v8
  v_dot2_f32_bf16 v57, v18, s42, v8
  v_cvt_pk_bf16_f32 v54, v52, v53
  v_lshlrev_b32 v48, 16, v50
  v_and_b32 v49, 0xffff0000, v50
  v_dot2_f32_bf16 v60, v19, s41, v8
  v_dot2_f32_bf16 v61, v19, s42, v8
  v_cvt_pk_bf16_f32 v58, v56, v57
  v_lshlrev_b32 v52, 16, v54
  v_and_b32 v53, 0xffff0000, v54
  v_pk_mul_f32 v[48:49], v[48:49], v[10:11]
  v_cvt_pk_bf16_f32 v16, v48, v49
  v_dot2_f32_bf16 v48, v20, s41, v8
  v_dot2_f32_bf16 v49, v20, s42, v8
  v_cvt_pk_bf16_f32 v62, v60, v61
  v_lshlrev_b32 v56, 16, v58
  v_and_b32 v57, 0xffff0000, v58
  v_pk_mul_f32 v[52:53], v[52:53], v[10:11]
  v_cvt_pk_bf16_f32 v17, v52, v53
  v_dot2_f32_bf16 v52, v21, s41, v8
  v_dot2_f32_bf16 v53, v21, s42, v8
  v_cvt_pk_bf16_f32 v50, v48, v49
  v_lshlrev_b32 v60, 16, v62
  v_and_b32 v61, 0xffff0000, v62
  v_pk_mul_f32 v[56:57], v[56:57], v[10:11]
  v_cvt_pk_bf16_f32 v18, v56, v57
  v_dot2_f32_bf16 v56, v22, s41, v8
  v_dot2_f32_bf16 v57, v22, s42, v8
  v_cvt_pk_bf16_f32 v54, v52, v53
  v_lshlrev_b32 v48, 16, v50
  v_and_b32 v49, 0xffff0000, v50
  v_pk_mul_f32 v[60:61], v[60:61], v[10:11]
  v_cvt_pk_bf16_f32 v19, v60, v61
  v_dot2_f32_bf16 v60, v23, s41, v8
  v_dot2_f32_bf16 v61, v23, s42, v8
  v_cvt_pk_bf16_f32 v58, v56, v57
  v_lshlrev_b32 v52, 16, v54
  v_and_b32 v53, 0xffff0000, v54
  v_pk_mul_f32 v[48:49], v[48:49], v[10:11]
  v_cvt_pk_bf16_f32 v20, v48, v49
  v_dot2_f32_bf16 v48, v24, s41, v8
  v_dot2_f32_bf16 v49, v24, s42, v8
  v_cvt_pk_bf16_f32 v62, v60, v61
  v_lshlrev_b32 v56, 16, v58
  v_and_b32 v57, 0xffff0000, v58
  v_pk_mul_f32 v[52:53], v[52:53], v[10:11]
  v_cvt_pk_bf16_f32 v21, v52, v53
  v_dot2_f32_bf16 v52, v25, s41, v8
  v_dot2_f32_bf16 v53, v25, s42, v8
  v_cvt_pk_bf16_f32 v50, v48, v49
  v_lshlrev_b32 v60, 16, v62
  v_and_b32 v61, 0xffff0000, v62
  v_pk_mul_f32 v[56:57], v[56:57], v[10:11]
  v_cvt_pk_bf16_f32 v22, v56, v57
  v_dot2_f32_bf16 v56, v26, s41, v8
  v_dot2_f32_bf16 v57, v26, s42, v8
  v_cvt_pk_bf16_f32 v54, v52, v53
  v_lshlrev_b32 v48, 16, v50
  v_and_b32 v49, 0xffff0000, v50
  v_pk_mul_f32 v[60:61], v[60:61], v[10:11]
  v_cvt_pk_bf16_f32 v23, v60, v61
  v_dot2_f32_bf16 v60, v27, s41, v8
  v_dot2_f32_bf16 v61, v27, s42, v8
  v_cvt_pk_bf16_f32 v58, v56, v57
  v_lshlrev_b32 v52, 16, v54
  v_and_b32 v53, 0xffff0000, v54
  v_pk_mul_f32 v[48:49], v[48:49], v[10:11]
  v_cvt_pk_bf16_f32 v24, v48, v49
  v_dot2_f32_bf16 v48, v28, s41, v8
  v_dot2_f32_bf16 v49, v28, s42, v8
  v_cvt_pk_bf16_f32 v62, v60, v61
  v_lshlrev_b32 v56, 16, v58
  v_and_b32 v57, 0xffff0000, v58
  v_pk_mul_f32 v[52:53], v[52:53], v[10:11]
  v_cvt_pk_bf16_f32 v25, v52, v53
  v_dot2_f32_bf16 v52, v29, s41, v8
  v_dot2_f32_bf16 v53, v29, s42, v8
  v_cvt_pk_bf16_f32 v50, v48, v49
  v_lshlrev_b32 v60, 16, v62
  v_and_b32 v61, 0xffff0000, v62
  v_pk_mul_f32 v[56:57], v[56:57], v[10:11]
  v_cvt_pk_bf16_f32 v26, v56, v57
  v_dot2_f32_bf16 v56, v30, s41, v8
  v_dot2_f32_bf16 v57, v30, s42, v8
  v_cvt_pk_bf16_f32 v54, v52, v53
  v_lshlrev_b32 v48, 16, v50
  v_and_b32 v49, 0xffff0000, v50
  v_pk_mul_f32 v[60:61], v[60:61], v[10:11]
  v_cvt_pk_bf16_f32 v27, v60, v61
  v_dot2_f32_bf16 v60, v31, s41, v8
  v_dot2_f32_bf16 v61, v31, s42, v8
  v_cvt_pk_bf16_f32 v58, v56, v57
  v_lshlrev_b32 v52, 16, v54
  v_and_b32 v53, 0xffff0000, v54
  v_pk_mul_f32 v[48:49], v[48:49], v[10:11]
  v_cvt_pk_bf16_f32 v28, v48, v49
  v_dot2_f32_bf16 v48, v32, s41, v8
  v_dot2_f32_bf16 v49, v32, s42, v8
  v_cvt_pk_bf16_f32 v62, v60, v61
  v_lshlrev_b32 v56, 16, v58
  v_and_b32 v57, 0xffff0000, v58
  v_pk_mul_f32 v[52:53], v[52:53], v[10:11]
  v_cvt_pk_bf16_f32 v29, v52, v53
  v_dot2_f32_bf16 v52, v33, s41, v8
  v_dot2_f32_bf16 v53, v33, s42, v8
  v_cvt_pk_bf16_f32 v50, v48, v49
  v_lshlrev_b32 v60, 16, v62
  v_and_b32 v61, 0xffff0000, v62
  v_pk_mul_f32 v[56:57], v[56:57], v[10:11]
  v_cvt_pk_bf16_f32 v30, v56, v57
  v_dot2_f32_bf16 v56, v34, s41, v8
  v_dot2_f32_bf16 v57, v34, s42, v8
  v_cvt_pk_bf16_f32 v54, v52, v53
  v_lshlrev_b32 v48, 16, v50
  v_and_b32 v49, 0xffff0000, v50
  v_pk_mul_f32 v[60:61], v[60:61], v[10:11]
  v_cvt_pk_bf16_f32 v31, v60, v61
  v_dot2_f32_bf16 v60, v35, s41, v8
  v_dot2_f32_bf16 v61, v35, s42, v8
  v_cvt_pk_bf16_f32 v58, v56, v57
  v_lshlrev_b32 v52, 16, v54
  v_and_b32 v53, 0xffff0000, v54
  v_pk_mul_f32 v[48:49], v[48:49], v[10:11]
  v_cvt_pk_bf16_f32 v32, v48, v49
  v_dot2_f32_bf16 v48, v36, s41, v8
  v_dot2_f32_bf16 v49, v36, s42, v8
  v_cvt_pk_bf16_f32 v62, v60, v61
  v_lshlrev_b32 v56, 16, v58
  v_and_b32 v57, 0xffff0000, v58
  v_pk_mul_f32 v[52:53], v[52:53], v[10:11]
  v_cvt_pk_bf16_f32 v33, v52, v53
  v_dot2_f32_bf16 v52, v37, s41, v8
  v_dot2_f32_bf16 v53, v37, s42, v8
  v_cvt_pk_bf16_f32 v50, v48, v49
  v_lshlrev_b32 v60, 16, v62
  v_and_b32 v61, 0xffff0000, v62
  v_pk_mul_f32 v[56:57], v[56:57], v[10:11]
  v_cvt_pk_bf16_f32 v34, v56, v57
  v_dot2_f32_bf16 v56, v38, s41, v8
  v_dot2_f32_bf16 v57, v38, s42, v8
  v_cvt_pk_bf16_f32 v54, v52, v53
  v_lshlrev_b32 v48, 16, v50
  v_and_b32 v49, 0xffff0000, v50
  v_pk_mul_f32 v[60:61], v[60:61], v[10:11]
  v_cvt_pk_bf16_f32 v35, v60, v61
  v_dot2_f32_bf16 v60, v39, s41, v8
  v_dot2_f32_bf16 v61, v39, s42, v8
  v_cvt_pk_bf16_f32 v58, v56, v57
  v_lshlrev_b32 v52, 16, v54
  v_and_b32 v53, 0xffff0000, v54
  v_pk_mul_f32 v[48:49], v[48:49], v[10:11]
  v_cvt_pk_bf16_f32 v36, v48, v49
  v_dot2_f32_bf16 v48, v40, s41, v8
  v_dot2_f32_bf16 v49, v40, s42, v8
  v_cvt_pk_bf16_f32 v62, v60, v61
  v_lshlrev_b32 v56, 16, v58
  v_and_b32 v57, 0xffff0000, v58
  v_pk_mul_f32 v[52:53], v[52:53], v[10:11]
  v_cvt_pk_bf16_f32 v37, v52, v53
  v_dot2_f32_bf16 v52, v41, s41, v8
  v_dot2_f32_bf16 v53, v41, s42, v8
  v_cvt_pk_bf16_f32 v50, v48, v49
  v_lshlrev_b32 v60, 16, v62
  v_and_b32 v61, 0xffff0000, v62
  v_pk_mul_f32 v[56:57], v[56:57], v[10:11]
  v_cvt_pk_bf16_f32 v38, v56, v57
  v_dot2_f32_bf16 v56, v42, s41, v8
  v_dot2_f32_bf16 v57, v42, s42, v8
  v_cvt_pk_bf16_f32 v54, v52, v53
  v_lshlrev_b32 v48, 16, v50
  v_and_b32 v49, 0xffff0000, v50
  v_pk_mul_f32 v[60:61], v[60:61], v[10:11]
  v_cvt_pk_bf16_f32 v39, v60, v61
  v_dot2_f32_bf16 v60, v43, s41, v8
  v_dot2_f32_bf16 v61, v43, s42, v8
  v_cvt_pk_bf16_f32 v58, v56, v57
  v_lshlrev_b32 v52, 16, v54
  v_and_b32 v53, 0xffff0000, v54
  v_pk_mul_f32 v[48:49], v[48:49], v[10:11]
  v_cvt_pk_bf16_f32 v40, v48, v49
  v_dot2_f32_bf16 v48, v44, s41, v8
  v_dot2_f32_bf16 v49, v44, s42, v8
  v_cvt_pk_bf16_f32 v62, v60, v61
  v_lshlrev_b32 v56, 16, v58
  v_and_b32 v57, 0xffff0000, v58
  v_pk_mul_f32 v[52:53], v[52:53], v[10:11]
  v_cvt_pk_bf16_f32 v41, v52, v53
  v_dot2_f32_bf16 v52, v45, s41, v8
  v_dot2_f32_bf16 v53, v45, s42, v8
  v_cvt_pk_bf16_f32 v50, v48, v49
  v_lshlrev_b32 v60, 16, v62
  v_and_b32 v61, 0xffff0000, v62
  v_pk_mul_f32 v[56:57], v[56:57], v[10:11]
  v_cvt_pk_bf16_f32 v42, v56, v57
  v_dot2_f32_bf16 v56, v46, s41, v8
  v_dot2_f32_bf16 v57, v46, s42, v8
  v_cvt_pk_bf16_f32 v54, v52, v53
  v_lshlrev_b32 v48, 16, v50
  v_and_b32 v49, 0xffff0000, v50
  v_pk_mul_f32 v[60:61], v[60:61], v[10:11]
  v_cvt_pk_bf16_f32 v43, v60, v61
  v_dot2_f32_bf16 v60, v47, s41, v8
  v_dot2_f32_bf16 v61, v47, s42, v8
  v_cvt_pk_bf16_f32 v58, v56, v57
  v_lshlrev_b32 v52, 16, v54
  v_and_b32 v53, 0xffff0000, v54
  v_pk_mul_f32 v[48:49], v[48:49], v[10:11]
  v_cvt_pk_bf16_f32 v44, v48, v49
  v_cvt_pk_bf16_f32 v62, v60, v61
  v_lshlrev_b32 v56, 16, v58
  v_and_b32 v57, 0xffff0000, v58
  v_pk_mul_f32 v[52:53], v[52:53], v[10:11]
  v_cvt_pk_bf16_f32 v45, v52, v53
  v_lshlrev_b32 v60, 16, v62
  v_and_b32 v61, 0xffff0000, v62
  v_pk_mul_f32 v[56:57], v[56:57], v[10:11]
  v_cvt_pk_bf16_f32 v46, v56, v57
  v_pk_mul_f32 v[60:61], v[60:61], v[10:11]
  v_cvt_pk_bf16_f32 v47, v60, v61
  s_cmp_lg_u32 s32, 0
  s_cbranch_scc1 A_NE
  global_load_dword v126, v127, s[82:83] sc1
A_NE:
  v_and_b32 v2, 31, v0
  v_lshrrev_b32 v3, 5, v0
  v_and_b32 v4, 15, v0
  v_xor_b32 v4, v4, v3
  v_lshlrev_b32 v4, 4, v4
  v_lshl_add_u32 v4, v2, 10, v4
  s_lshr_b32 s44, s32, 2
  s_bfe_u32 s45, s32, 0x10001
  s_and_b32 s46, s32, 1
  s_lshl_b32 s36, s44, 15
  s_lshl_b32 s37, s46, 9
  s_add_u32 s36, s36, s37
  v_add_u32 v14, s36, v4
  v_bfe_u32 v8, v0, 4, 1
  v_bfe_u32 v9, v0, 2, 2
  v_and_b32 v10, 3, v0
  v_lshrrev_b32 v11, 1, v10
  v_lshl_add_u32 v11, v8, 1, v11
  s_lshl_b32 s36, s45, 2
  v_add_u32 v11, s36, v11
  v_lshrrev_b32 v15, 1, v9
  v_lshlrev_b32 v15, 2, v15
  v_xor_b32 v11, v11, v15
  v_lshlrev_b32 v11, 4, v11
  v_and_b32 v15, 1, v10
  v_lshl_add_u32 v11, v15, 3, v11
  v_lshl_add_u32 v15, v3, 3, v9
  v_lshl_add_u32 v15, v15, 7, v11
  s_lshl_b32 s36, s46, 15
  v_add_u32 v15, s36, v15
  s_and_b32 s47, s32, 1
  s_lshr_b32 s48, s32, 1
  s_lshl_b32 s36, s34, 2
  s_add_u32 s48, s48, s36
  s_and_b32 s36, s48, 7
  s_lshl_b32 s36, s36, 5
  v_xor_b32 v124, s36, v4
  s_lshr_b32 s36, s48, 3
  s_lshl_b32 s36, s36, 8
  s_lshl_b32 s37, s47, 15
  s_add_u32 s36, s36, s37
  v_add_u32 v124, s36, v124
  s_lshl_b32 s36, s33, 1
  s_add_u32 s36, s36, s47
  s_lshl_b32 s36, s36, 5
  s_add_u32 s36, s36, s48
  s_lshl_b32 s36, s36, 10
  s_add_u32 s49, s36, 0
  v_xor_b32 v112, 0, v14
  v_xor_b32 v113, 32, v14
  v_xor_b32 v114, 64, v14
  v_xor_b32 v115, 96, v14
  v_xor_b32 v116, 128, v14
  v_xor_b32 v117, 160, v14
  v_xor_b32 v118, 192, v14
  v_xor_b32 v119, 224, v14
  s_waitcnt vmcnt(0)
  s_barrier
  ds_read_b64_tr_b16 v[48:49], v15 offset:0
  ds_read_b64_tr_b16 v[50:51], v15 offset:512
  ds_read_b64_tr_b16 v[52:53], v15 offset:2048
  ds_read_b64_tr_b16 v[54:55], v15 offset:2560
  ds_read_b64_tr_b16 v[56:57], v15 offset:4096
  ds_read_b64_tr_b16 v[58:59], v15 offset:4608
  ds_read_b64_tr_b16 v[60:61], v15 offset:6144
  ds_read_b64_tr_b16 v[62:63], v15 offset:6656
  ds_read_b64_tr_b16 v[64:65], v15 offset:8192
  ds_read_b64_tr_b16 v[66:67], v15 offset:8704
  ds_read_b64_tr_b16 v[68:69], v15 offset:10240
  ds_read_b64_tr_b16 v[70:71], v15 offset:10752
  ds_read_b64_tr_b16 v[72:73], v15 offset:12288
  ds_read_b64_tr_b16 v[74:75], v15 offset:12800
  ds_read_b64_tr_b16 v[76:77], v15 offset:14336
  ds_read_b64_tr_b16 v[78:79], v15 offset:14848
  ds_read_b64_tr_b16 v[80:81], v15 offset:16384
  ds_read_b64_tr_b16 v[82:83], v15 offset:16896
  ds_read_b64_tr_b16 v[84:85], v15 offset:18432
  ds_read_b64_tr_b16 v[86:87], v15 offset:18944
  ds_read_b64_tr_b16 v[88:89], v15 offset:20480
  ds_read_b64_tr_b16 v[90:91], v15 offset:20992
  ds_read_b64_tr_b16 v[92:93], v15 offset:22528
  ds_read_b64_tr_b16 v[94:95], v15 offset:23040
  ds_read_b64_tr_b16 v[96:97], v15 offset:24576
  ds_read_b64_tr_b16 v[98:99], v15 offset:25088
  ds_read_b64_tr_b16 v[100:101], v15 offset:26624
  ds_read_b64_tr_b16 v[102:103], v15 offset:27136
  ds_read_b64_tr_b16 v[104:105], v15 offset:28672
  ds_read_b64_tr_b16 v[106:107], v15 offset:29184
  ds_read_b64_tr_b16 v[108:109], v15 offset:30720
  ds_read_b64_tr_b16 v[110:111], v15 offset:31232
  s_waitcnt lgkmcnt(0)
  s_barrier
  ds_write_b128 v12, v[16:19] offset:0
  ds_write_b128 v13, v[20:23] offset:0
  ds_write_b128 v12, v[24:27] offset:256
  ds_write_b128 v13, v[28:31] offset:256
  ds_write_b128 v12, v[32:35] offset:512
  ds_write_b128 v13, v[36:39] offset:512
  ds_write_b128 v12, v[40:43] offset:768
  ds_write_b128 v13, v[44:47] offset:768
  s_waitcnt lgkmcnt(0)
  s_barrier
  ds_read_b128 v[120:123], v124
  v_lshlrev_b32 v8, 2, v0
  s_and_b32 s36, s2, 7
  s_lshl_b32 s36, s36, 8
  s_add_u32 s36, s36, 0xf00000
  v_add_u32 v8, s36, v8
  s_cmp_lg_u32 s32, 0
  s_cbranch_scc1 A_NOKV1
  global_load_dword v10, v8, s[14:15] sc1
A_NOKV1:
  s_waitcnt lgkmcnt(0)
  buffer_store_dwordx4 v[120:123], v1, s[28:31], s49 offen sc1
  ds_read_b128 v[32:35], v112 offset:0
  ds_read_b128 v[36:39], v113 offset:0
  ds_read_b128 v[40:43], v114 offset:0
  ds_read_b128 v[44:47], v115 offset:0
  s_waitcnt lgkmcnt(3)
  v_mfma_f32_32x32x16_bf16 v[16:31], v[48:51], v[32:35], 0
  ds_read_b128 v[32:35], v116 offset:0
  s_waitcnt lgkmcnt(3)
  v_mfma_f32_32x32x16_bf16 v[16:31], v[52:55], v[36:39], v[16:31]
  ds_read_b128 v[36:39], v117 offset:0
  s_waitcnt lgkmcnt(3)
  v_mfma_f32_32x32x16_bf16 v[16:31], v[56:59], v[40:43], v[16:31]
  ds_read_b128 v[40:43], v118 offset:0
  s_waitcnt lgkmcnt(3)
  v_mfma_f32_32x32x16_bf16 v[16:31], v[60:63], v[44:47], v[16:31]
  ds_read_b128 v[44:47], v119 offset:0
  s_waitcnt lgkmcnt(3)
  v_mfma_f32_32x32x16_bf16 v[16:31], v[64:67], v[32:35], v[16:31]
  ds_read_b128 v[32:35], v112 offset:256
  s_waitcnt lgkmcnt(3)
  v_mfma_f32_32x32x16_bf16 v[16:31], v[68:71], v[36:39], v[16:31]
  ds_read_b128 v[36:39], v113 offset:256
  s_waitcnt lgkmcnt(3)
  v_mfma_f32_32x32x16_bf16 v[16:31], v[72:75], v[40:43], v[16:31]
  ds_read_b128 v[40:43], v114 offset:256
  s_waitcnt lgkmcnt(3)
  v_mfma_f32_32x32x16_bf16 v[16:31], v[76:79], v[44:47], v[16:31]
  ds_read_b128 v[44:47], v115 offset:256
  s_waitcnt lgkmcnt(3)
  v_mfma_f32_32x32x16_bf16 v[16:31], v[80:83], v[32:35], v[16:31]
  ds_read_b128 v[32:35], v116 offset:256
  s_waitcnt lgkmcnt(3)
  v_mfma_f32_32x32x16_bf16 v[16:31], v[84:87], v[36:39], v[16:31]
  ds_read_b128 v[36:39], v117 offset:256
  s_waitcnt lgkmcnt(3)
  v_mfma_f32_32x32x16_bf16 v[16:31], v[88:91], v[40:43], v[16:31]
  ds_read_b128 v[40:43], v118 offset:256
  s_waitcnt lgkmcnt(3)
  v_mfma_f32_32x32x16_bf16 v[16:31], v[92:95], v[44:47], v[16:31]
  ds_read_b128 v[44:47], v119 offset:256
  s_waitcnt lgkmcnt(3)
  v_mfma_f32_32x32x16_bf16 v[16:31], v[96:99], v[32:35], v[16:31]
  s_waitcnt lgkmcnt(2)
  v_mfma_f32_32x32x16_bf16 v[16:31], v[100:103], v[36:39], v[16:31]
  s_waitcnt lgkmcnt(1)
  v_mfma_f32_32x32x16_bf16 v[16:31], v[104:107], v[40:43], v[16:31]
  s_waitcnt lgkmcnt(0)
  v_mfma_f32_32x32x16_bf16 v[16:31], v[108:111], v[44:47], v[16:31]
  s_cmp_lg_u32 s32, 0
  s_cbranch_scc1 A_NOKVW
  s_mov_b32 s39, 65536
  s_waitcnt vmcnt(0)
NON2:
  v_readfirstlane_b32 s80, v126
  s_cmp_lg_u32 s80, 0
  s_cbranch_scc1 NON2_OK
  s_sleep 1
  global_load_dword v126, v127, s[82:83] sc1
  s_waitcnt vmcnt(0)
  s_sub_u32 s39, s39, 1
  s_cmp_lg_u32 s39, 0
  s_cbranch_scc1 NON2
NON2_OK:
  s_mov_b32 s39, 65536
  s_mov_b64 exec, -1
  s_branch FW3_C
FW3:
  global_load_dword v10, v8, s[14:15] sc1
FW3_C:
  s_waitcnt vmcnt(0)
  v_cmp_ne_u32 vcc, s80, v10
  s_nop 4
  s_cbranch_vccz FW3_OK
  s_sleep 2
  s_sub_u32 s39, s39, 1
  s_cmp_lg_u32 s39, 0
  s_cbranch_scc1 FW3
FW3_OK:
  s_mov_b64 exec, -1
A_NOKVW:
  s_waitcnt vmcnt(0)
  s_barrier
  s_cmp_lg_u32 s32, 0
  s_cbranch_scc1 A_NOSIG
  s_lshl_b32 s36, s33, 5
  s_add_u32 s36, s36, s34
  s_lshl_b32 s36, s36, 2
  s_add_u32 s36, s36, 0xf01000
  v_mov_b32 v124, s36
  v_mov_b32 v125, s80
  s_mov_b64 exec, 1
  global_store_dword v124, v125, s[14:15] sc1
  s_mov_b64 exec, -1
A_NOSIG:
  s_lshl_b32 s60, s32, 10
  s_add_u32 s61, s60, 4194304
  s_add_u32 s60, s60, 65536
  s_mov_b32 m0, s60
  s_nop 0
  buffer_load_dwordx4 v1, s[28:31], s61 offen sc1 lds
  s_add_u32 s61, s61, 8192
  s_add_u32 s60, s60, 8192
  s_mov_b32 m0, s60
  s_nop 0
  buffer_load_dwordx4 v1, s[28:31], s61 offen sc1 lds
  s_add_u32 s61, s61, 8192
  s_sub_u32 s60, s60, 73728
  s_mov_b32 m0, s60
  s_nop 0
  buffer_load_dwordx4 v1, s[28:31], s61 offen sc1 lds
  s_add_u32 s61, s61, 8192
  s_add_u32 s60, s60, 8192
  s_lshl_b32 s36, s32, 11
  s_add_u32 s36, s36, 16384
  v_add_u32 v12, s36, v1
  v_xor_b32 v13, 2048, v12
  s_cmp_eq_u32 s46, 0
  s_cbranch_scc1 A_QX0
  ds_write_b128 v12, v[16:19]
  ds_write_b128 v12, v[20:23] offset:1024
  s_branch A_QX1
A_QX0:
  ds_write_b128 v12, v[24:27]
  ds_write_b128 v12, v[28:31] offset:1024
A_QX1:
  s_waitcnt lgkmcnt(0)
  s_barrier
  ds_read_b128 v[80:83], v13
  ds_read_b128 v[84:87], v13 offset:1024
  s_mov_b32 s40, 0x3eb8aa3b
  s_cmp_eq_u32 s46, 0
  s_cbranch_scc1 A_QY0
  s_waitcnt lgkmcnt(1)
  v_add_f32 v80, v80, v24
  v_add_f32 v81, v81, v25
  v_add_f32 v82, v82, v26
  v_add_f32 v83, v83, v27
  s_waitcnt lgkmcnt(0)
  v_add_f32 v84, v84, v28
  v_add_f32 v85, v85, v29
  v_add_f32 v86, v86, v30
  v_add_f32 v87, v87, v31
  s_branch A_QY1
A_QY0:
  s_waitcnt lgkmcnt(1)
  v_add_f32 v80, v80, v16
  v_add_f32 v81, v81, v17
  v_add_f32 v82, v82, v18
  v_add_f32 v83, v83, v19
  s_waitcnt lgkmcnt(0)
  v_add_f32 v84, v84, v20
  v_add_f32 v85, v85, v21
  v_add_f32 v86, v86, v22
  v_add_f32 v87, v87, v23
A_QY1:
  v_mul_f32 v80, s40, v80
  v_mul_f32 v81, s40, v81
  v_mul_f32 v82, s40, v82
  v_mul_f32 v83, s40, v83
  v_mul_f32 v84, s40, v84
  v_mul_f32 v85, s40, v85
  v_mul_f32 v86, s40, v86
  v_mul_f32 v87, s40, v87
  v_cvt_pk_bf16_f32 v4, v80, v81
  v_cvt_pk_bf16_f32 v5, v82, v83
  v_cvt_pk_bf16_f32 v6, v84, v85
  v_cvt_pk_bf16_f32 v7, v86, v87
  s_lshr_b32 s38, s32, 2
  s_lshl_b32 s39, s33, 1
  s_add_u32 s38, s38, s39
  s_lshl_b32 s38, s38, 5
  s_lshl_b32 s39, s34, 2
  s_add_u32 s38, s38, s39
  s_and_b32 s39, s32, 3
  s_add_u32 s38, s38, s39
  s_lshl_b32 s38, s38, 10
  v_and_b32 v2, 31, v0
  v_cmp_eq_u32 vcc, 16, v2
  v_mov_b32 v3, 0x3f803f80
  s_nop 0
  v_cndmask_b32 v16, 0, v3, vcc
  v_cndmask_b32 v17, 0, v3, vcc
  v_cndmask_b32 v18, 0, v3, vcc
  v_cndmask_b32 v19, 0, v3, vcc
  v_cndmask_b32 v20, 0, v3, vcc
  v_cndmask_b32 v21, 0, v3, vcc
  v_cndmask_b32 v22, 0, v3, vcc
  v_cndmask_b32 v23, 0, v3, vcc
  v_cndmask_b32 v24, 0, v3, vcc
  v_cndmask_b32 v25, 0, v3, vcc
  v_cndmask_b32 v26, 0, v3, vcc
  v_cndmask_b32 v27, 0, v3, vcc
  v_cndmask_b32 v28, 0, v3, vcc
  v_cndmask_b32 v29, 0, v3, vcc
  v_cndmask_b32 v30, 0, v3, vcc
  v_cndmask_b32 v31, 0, v3, vcc
  v_mov_b32 v80, 0
  v_mov_b32 v81, 0
  v_mov_b32 v82, 0
  v_mov_b32 v83, 0
  v_mov_b32 v84, 0
  v_mov_b32 v85, 0
  v_mov_b32 v86, 0
  v_mov_b32 v87, 0
  v_mov_b32 v88, 0
  v_mov_b32 v89, 0
  v_mov_b32 v90, 0
  v_mov_b32 v91, 0
  v_mov_b32 v92, 0
  v_mov_b32 v93, 0
  v_mov_b32 v94, 0
  v_mov_b32 v95, 0
  v_mov_b32 v40, 0
  v_mov_b32 v41, 0
  v_mov_b32 v42, 0
  v_mov_b32 v43, 0
  v_mov_b32 v44, 0
  v_mov_b32 v45, 0
  v_mov_b32 v46, 0
  v_mov_b32 v47, 0
  v_and_b32 v2, 15, v0
  v_lshrrev_b32 v3, 5, v0
  v_lshlrev_b32 v2, 4, v2
  v_lshl_add_u32 v2, v3, 8, v2
  v_add_u32 v113, 65536, v1
  v_mov_b32 v114, v1
  v_add_u32 v115, 65536, v2
  s_mov_b32 s40, 0xffff
  s_mov_b32 s41, 0xffff
  s_waitcnt vmcnt(0)
  s_barrier
  s_mov_b32 m0, s60
  s_nop 0
  buffer_load_dwordx4 v1, s[28:31], s61 offen sc1 lds
  s_add_u32 s60, s60, 8192
  s_add_u32 s61, s61, 8192
  s_mov_b32 m0, s60
  s_nop 0
  buffer_load_dwordx4 v1, s[28:31], s61 offen sc1 lds
  s_add_u32 s60, s60, 8192
  s_add_u32 s61, s61, 8192
  s_mov_b32 m0, s60
  s_nop 0
  buffer_load_dwordx4 v1, s[28:31], s61 offen sc1 lds
  s_add_u32 s60, s60, 8192
  s_add_u32 s61, s61, 8192
  s_mov_b32 m0, s60
  s_nop 0
  buffer_load_dwordx4 v1, s[28:31], s61 offen sc1 lds
  s_add_u32 s60, s60, 8192
  s_add_u32 s61, s61, 8192
  s_mov_b32 m0, s60
  s_nop 0
  buffer_load_dwordx4 v1, s[28:31], s61 offen sc1 lds
  s_add_u32 s60, s60, 8192
  s_add_u32 s61, s61, 8192
  s_mov_b32 m0, s60
  s_nop 0
  buffer_load_dwordx4 v1, s[28:31], s61 offen sc1 lds
  s_add_u32 s60, s60, 8192
  s_add_u32 s61, s61, 8192
  s_mov_b32 m0, s60
  s_nop 0
  buffer_load_dwordx4 v1, s[28:31], s61 offen sc1 lds
  s_add_u32 s60, s60, 8192
  s_add_u32 s61, s61, 8192
  ds_read_b128 v[8:11], v113 offset:0
  ds_read_b128 v[12:15], v113 offset:2048
  s_waitcnt lgkmcnt(1)
  v_mfma_f32_32x32x16_bf16 v[48:63], v[8:11], v[4:7], 0
  s_waitcnt lgkmcnt(0)
  v_mfma_f32_32x32x16_bf16 v[64:79], v[12:15], v[4:7], 0
  s_nop 9
  v_max3_f32 v3, v48, v49, v50
  v_max3_f32 v112, v51, v52, v53
  v_max3_f32 v3, v3, v54, v55
  v_max3_f32 v112, v112, v56, v57
  v_max3_f32 v3, v3, v58, v59
  v_max3_f32 v112, v112, v60, v61
  v_max3_f32 v3, v3, v62, v63
  v_max3_f32 v112, v112, v64, v65
  v_max3_f32 v3, v3, v66, v67
  v_max3_f32 v112, v112, v68, v69
  v_max3_f32 v3, v3, v70, v71
  v_max3_f32 v112, v112, v72, v73
  v_max3_f32 v3, v3, v74, v75
  v_max3_f32 v112, v112, v76, v77
  v_max3_f32 v3, v3, v78, v79
  v_max_f32 v3, v3, v112
  v_mov_b32 v112, v3
  s_nop 1
  v_permlane32_swap_b32 v3, v112
  v_max_f32 v3, v3, v112
  v_add_f32 v3, 0x42c80000, v3
  v_sub_f32 v96, 0, v3
  v_sub_f32 v97, 0, v3
  v_sub_f32 v98, 0, v3
  v_sub_f32 v99, 0, v3
  v_sub_f32 v100, 0, v3
  v_sub_f32 v101, 0, v3
  v_sub_f32 v102, 0, v3
  v_sub_f32 v103, 0, v3
  v_sub_f32 v104, 0, v3
  v_sub_f32 v105, 0, v3
  v_sub_f32 v106, 0, v3
  v_sub_f32 v107, 0, v3
  v_sub_f32 v108, 0, v3
  v_sub_f32 v109, 0, v3
  v_sub_f32 v110, 0, v3
  v_sub_f32 v111, 0, v3
  s_nop 1
  v_mfma_f32_32x32x16_bf16 v[48:63], v[8:11], v[4:7], v[96:111]
  s_mov_b32 s43, 0
  s_nop 11
  s_branch A_BODY
A_LOOP:
  s_cmp_eq_u32 s43, 1
  s_cbranch_scc1 A_B1
  s_cmp_lt_u32 s43, 3
  s_cbranch_scc1 A_BODY
  s_cmp_eq_u32 s43, 3
  s_cbranch_scc1 A_B2
  s_cmp_eq_u32 s43, 4
  s_cbranch_scc1 A_B3
  s_cmp_eq_u32 s43, 5
  s_cbranch_scc1 A_B4
  s_cmp_eq_u32 s43, 6
  s_cbranch_scc1 A_B5
A_BODY:
  s_setprio 3
  s_waitcnt lgkmcnt(2)
  v_mfma_f32_32x32x16_bf16 v[64:79], v[12:15], v[4:7], v[96:111]
  ds_read_b128 v[8:11], v113 offset:4096
  v_exp_f32 v48, v48
  v_exp_f32 v49, v49
  s_mov_b64 exec, s[40:41]
  ds_read_b128 v[16:19], v115 offset:1024
  ds_read_b128 v[20:23], v115 offset:1536
  s_mov_b64 exec, -1
  v_exp_f32 v50, v50
  v_exp_f32 v51, v51
  v_exp_f32 v52, v52
  v_exp_f32 v53, v53
  v_cvt_pk_bf16_f32 v32, v48, v49
  v_cvt_pk_bf16_f32 v33, v50, v51
  s_waitcnt lgkmcnt(4)
  v_mfma_f32_32x32x16_bf16 v[80:95], v[24:27], v[40:43], v[80:95]
  v_exp_f32 v54, v54
  v_exp_f32 v55, v55
  v_exp_f32 v56, v56
  v_cvt_pk_bf16_f32 v34, v52, v53
  v_exp_f32 v57, v57
  v_cvt_pk_bf16_f32 v35, v54, v55
  s_waitcnt lgkmcnt(3)
  v_mfma_f32_32x32x16_bf16 v[80:95], v[28:31], v[44:47], v[80:95]
  v_exp_f32 v58, v58
  v_exp_f32 v59, v59
  v_exp_f32 v60, v60
  v_cvt_pk_bf16_f32 v36, v56, v57
  v_exp_f32 v61, v61
  v_cvt_pk_bf16_f32 v37, v58, v59
  v_exp_f32 v62, v62
  v_exp_f32 v63, v63
  v_cvt_pk_bf16_f32 v38, v60, v61
  v_cvt_pk_bf16_f32 v39, v62, v63
  s_setprio 2
  s_waitcnt lgkmcnt(2)
  v_mfma_f32_32x32x16_bf16 v[48:63], v[8:11], v[4:7], v[96:111]
  ds_read_b128 v[12:15], v113 offset:6144
  v_exp_f32 v64, v64
  v_exp_f32 v65, v65
  s_mov_b64 exec, s[40:41]
  ds_read_b128 v[24:27], v115 offset:3072
  ds_read_b128 v[28:31], v115 offset:3584
  s_mov_b64 exec, -1
  v_exp_f32 v66, v66
  v_exp_f32 v67, v67
  v_exp_f32 v68, v68
  v_exp_f32 v69, v69
  v_cvt_pk_bf16_f32 v40, v64, v65
  v_cvt_pk_bf16_f32 v41, v66, v67
  s_waitcnt lgkmcnt(4)
  v_mfma_f32_32x32x16_bf16 v[80:95], v[16:19], v[32:35], v[80:95]
  v_exp_f32 v70, v70
  v_exp_f32 v71, v71
  v_exp_f32 v72, v72
  v_cvt_pk_bf16_f32 v42, v68, v69
  v_exp_f32 v73, v73
  v_cvt_pk_bf16_f32 v43, v70, v71
  s_waitcnt lgkmcnt(3)
  v_mfma_f32_32x32x16_bf16 v[80:95], v[20:23], v[36:39], v[80:95]
  v_exp_f32 v74, v74
  v_exp_f32 v75, v75
  v_exp_f32 v76, v76
  v_cvt_pk_bf16_f32 v44, v72, v73
  v_exp_f32 v77, v77
  v_cvt_pk_bf16_f32 v45, v74, v75
  v_exp_f32 v78, v78
  v_exp_f32 v79, v79
  v_cvt_pk_bf16_f32 v46, v76, v77
  v_cvt_pk_bf16_f32 v47, v78, v79
  s_setprio 1
  s_waitcnt lgkmcnt(2)
  v_mfma_f32_32x32x16_bf16 v[64:79], v[12:15], v[4:7], v[96:111]
  ds_read_b128 v[8:11], v113 offset:8192
  v_exp_f32 v48, v48
  v_exp_f32 v49, v49
  s_mov_b64 exec, s[40:41]
  ds_read_b128 v[16:19], v115 offset:5120
  ds_read_b128 v[20:23], v115 offset:5632
  s_mov_b64 exec, -1
  v_exp_f32 v50, v50
  v_exp_f32 v51, v51
  v_exp_f32 v52, v52
  v_exp_f32 v53, v53
  v_cvt_pk_bf16_f32 v32, v48, v49
  v_cvt_pk_bf16_f32 v33, v50, v51
  s_waitcnt lgkmcnt(4)
  v_mfma_f32_32x32x16_bf16 v[80:95], v[24:27], v[40:43], v[80:95]
  v_exp_f32 v54, v54
  v_exp_f32 v55, v55
  v_exp_f32 v56, v56
  v_cvt_pk_bf16_f32 v34, v52, v53
  v_exp_f32 v57, v57
  v_cvt_pk_bf16_f32 v35, v54, v55
  s_waitcnt lgkmcnt(3)
  v_mfma_f32_32x32x16_bf16 v[80:95], v[28:31], v[44:47], v[80:95]
  v_exp_f32 v58, v58
  v_exp_f32 v59, v59
  v_exp_f32 v60, v60
  v_cvt_pk_bf16_f32 v36, v56, v57
  v_exp_f32 v61, v61
  v_cvt_pk_bf16_f32 v37, v58, v59
  v_exp_f32 v62, v62
  v_exp_f32 v63, v63
  v_cvt_pk_bf16_f32 v38, v60, v61
  v_cvt_pk_bf16_f32 v39, v62, v63
  s_setprio 0
  s_waitcnt lgkmcnt(2)
  v_mfma_f32_32x32x16_bf16 v[48:63], v[8:11], v[4:7], v[96:111]
  ds_read_b128 v[12:15], v113 offset:10240
  v_exp_f32 v64, v64
  v_exp_f32 v65, v65
  s_mov_b64 exec, s[40:41]
  ds_read_b128 v[24:27], v115 offset:7168
  ds_read_b128 v[28:31], v115 offset:7680
  s_mov_b64 exec, -1
  v_exp_f32 v66, v66
  v_exp_f32 v67, v67
  v_exp_f32 v68, v68
  v_exp_f32 v69, v69
  v_cvt_pk_bf16_f32 v40, v64, v65
  v_cvt_pk_bf16_f32 v41, v66, v67
  s_waitcnt lgkmcnt(4)
  v_mfma_f32_32x32x16_bf16 v[80:95], v[16:19], v[32:35], v[80:95]
  v_exp_f32 v70, v70
  v_exp_f32 v71, v71
  v_exp_f32 v72, v72
  v_cvt_pk_bf16_f32 v42, v68, v69
  v_exp_f32 v73, v73
  v_cvt_pk_bf16_f32 v43, v70, v71
  s_waitcnt lgkmcnt(3)
  v_mfma_f32_32x32x16_bf16 v[80:95], v[20:23], v[36:39], v[80:95]
  v_exp_f32 v74, v74
  v_exp_f32 v75, v75
  v_exp_f32 v76, v76
  v_cvt_pk_bf16_f32 v44, v72, v73
  v_exp_f32 v77, v77
  v_cvt_pk_bf16_f32 v45, v74, v75
  v_exp_f32 v78, v78
  v_exp_f32 v79, v79
  v_cvt_pk_bf16_f32 v46, v76, v77
  v_cvt_pk_bf16_f32 v47, v78, v79
  s_setprio 3
  s_waitcnt lgkmcnt(2)
  v_mfma_f32_32x32x16_bf16 v[64:79], v[12:15], v[4:7], v[96:111]
  ds_read_b128 v[8:11], v113 offset:12288
  v_exp_f32 v48, v48
  v_exp_f32 v49, v49
  s_mov_b64 exec, s[40:41]
  ds_read_b128 v[16:19], v115 offset:9216
  ds_read_b128 v[20:23], v115 offset:9728
  s_mov_b64 exec, -1
  v_exp_f32 v50, v50
  v_exp_f32 v51, v51
  v_exp_f32 v52, v52
  v_exp_f32 v53, v53
  v_cvt_pk_bf16_f32 v32, v48, v49
  v_cvt_pk_bf16_f32 v33, v50, v51
  s_waitcnt lgkmcnt(4)
  v_mfma_f32_32x32x16_bf16 v[80:95], v[24:27], v[40:43], v[80:95]
  v_exp_f32 v54, v54
  v_exp_f32 v55, v55
  v_exp_f32 v56, v56
  v_cvt_pk_bf16_f32 v34, v52, v53
  v_exp_f32 v57, v57
  v_cvt_pk_bf16_f32 v35, v54, v55
  s_waitcnt lgkmcnt(3)
  v_mfma_f32_32x32x16_bf16 v[80:95], v[28:31], v[44:47], v[80:95]
  v_exp_f32 v58, v58
  v_exp_f32 v59, v59
  v_exp_f32 v60, v60
  v_cvt_pk_bf16_f32 v36, v56, v57
  v_exp_f32 v61, v61
  v_cvt_pk_bf16_f32 v37, v58, v59
  v_exp_f32 v62, v62
  v_exp_f32 v63, v63
  v_cvt_pk_bf16_f32 v38, v60, v61
  v_cvt_pk_bf16_f32 v39, v62, v63
  s_setprio 2
  s_waitcnt lgkmcnt(2)
  v_mfma_f32_32x32x16_bf16 v[48:63], v[8:11], v[4:7], v[96:111]
  ds_read_b128 v[12:15], v113 offset:14336
  v_exp_f32 v64, v64
  v_exp_f32 v65, v65
  s_mov_b64 exec, s[40:41]
  ds_read_b128 v[24:27], v115 offset:11264
  ds_read_b128 v[28:31], v115 offset:11776
  s_mov_b64 exec, -1
  v_exp_f32 v66, v66
  v_exp_f32 v67, v67
  v_exp_f32 v68, v68
  v_exp_f32 v69, v69
  v_cvt_pk_bf16_f32 v40, v64, v65
  v_cvt_pk_bf16_f32 v41, v66, v67
  s_waitcnt lgkmcnt(4)
  v_mfma_f32_32x32x16_bf16 v[80:95], v[16:19], v[32:35], v[80:95]
  v_exp_f32 v70, v70
  v_exp_f32 v71, v71
  v_exp_f32 v72, v72
  v_cvt_pk_bf16_f32 v42, v68, v69
  v_exp_f32 v73, v73
  v_cvt_pk_bf16_f32 v43, v70, v71
  s_waitcnt lgkmcnt(3)
  v_mfma_f32_32x32x16_bf16 v[80:95], v[20:23], v[36:39], v[80:95]
  v_exp_f32 v74, v74
  v_exp_f32 v75, v75
  v_exp_f32 v76, v76
  v_cvt_pk_bf16_f32 v44, v72, v73
  v_exp_f32 v77, v77
  v_cvt_pk_bf16_f32 v45, v74, v75
  v_exp_f32 v78, v78
  v_exp_f32 v79, v79
  v_cvt_pk_bf16_f32 v46, v76, v77
  v_cvt_pk_bf16_f32 v47, v78, v79
  s_setprio 1
  s_waitcnt lgkmcnt(2)
  v_mfma_f32_32x32x16_bf16 v[64:79], v[12:15], v[4:7], v[96:111]
  ds_read_b128 v[8:11], v114 offset:0
  v_exp_f32 v48, v48
  v_exp_f32 v49, v49
  s_mov_b64 exec, s[40:41]
  ds_read_b128 v[16:19], v115 offset:13312
  ds_read_b128 v[20:23], v115 offset:13824
  s_mov_b64 exec, -1
  v_exp_f32 v50, v50
  v_exp_f32 v51, v51
  v_exp_f32 v52, v52
  v_exp_f32 v53, v53
  v_cvt_pk_bf16_f32 v32, v48, v49
  v_cvt_pk_bf16_f32 v33, v50, v51
  s_waitcnt lgkmcnt(4)
  v_mfma_f32_32x32x16_bf16 v[80:95], v[24:27], v[40:43], v[80:95]
  v_exp_f32 v54, v54
  v_exp_f32 v55, v55
  v_exp_f32 v56, v56
  v_cvt_pk_bf16_f32 v34, v52, v53
  v_exp_f32 v57, v57
  v_cvt_pk_bf16_f32 v35, v54, v55
  s_waitcnt lgkmcnt(3)
  v_mfma_f32_32x32x16_bf16 v[80:95], v[28:31], v[44:47], v[80:95]
  v_exp_f32 v58, v58
  v_exp_f32 v59, v59
  v_exp_f32 v60, v60
  v_cvt_pk_bf16_f32 v36, v56, v57
  v_exp_f32 v61, v61
  v_cvt_pk_bf16_f32 v37, v58, v59
  v_exp_f32 v62, v62
  v_exp_f32 v63, v63
  v_cvt_pk_bf16_f32 v38, v60, v61
  v_cvt_pk_bf16_f32 v39, v62, v63
  s_setprio 0
  s_waitcnt lgkmcnt(2)
  v_mfma_f32_32x32x16_bf16 v[48:63], v[8:11], v[4:7], v[96:111]
  ds_read_b128 v[12:15], v114 offset:2048
  v_exp_f32 v64, v64
  v_exp_f32 v65, v65
  s_mov_b64 exec, s[40:41]
  ds_read_b128 v[24:27], v115 offset:15360
  ds_read_b128 v[28:31], v115 offset:15872
  s_mov_b64 exec, -1
  v_exp_f32 v66, v66
  v_exp_f32 v67, v67
  v_exp_f32 v68, v68
  v_exp_f32 v69, v69
  v_cvt_pk_bf16_f32 v40, v64, v65
  v_cvt_pk_bf16_f32 v41, v66, v67
  s_waitcnt lgkmcnt(4)
  v_mfma_f32_32x32x16_bf16 v[80:95], v[16:19], v[32:35], v[80:95]
  v_exp_f32 v70, v70
  v_exp_f32 v71, v71
  v_exp_f32 v72, v72
  v_cvt_pk_bf16_f32 v42, v68, v69
  v_exp_f32 v73, v73
  v_cvt_pk_bf16_f32 v43, v70, v71
  s_waitcnt lgkmcnt(3)
  v_mfma_f32_32x32x16_bf16 v[80:95], v[20:23], v[36:39], v[80:95]
  v_exp_f32 v74, v74
  v_exp_f32 v75, v75
  v_exp_f32 v76, v76
  v_cvt_pk_bf16_f32 v44, v72, v73
  v_exp_f32 v77, v77
  v_cvt_pk_bf16_f32 v45, v74, v75
  v_exp_f32 v78, v78
  v_exp_f32 v79, v79
  v_cvt_pk_bf16_f32 v46, v76, v77
  v_cvt_pk_bf16_f32 v47, v78, v79
  v_add_u32 v113, 16384, v113
  v_add_u32 v114, 16384, v114
  v_add_u32 v115, 16384, v115
  s_add_u32 s43, s43, 1
  s_cmp_lt_u32 s43, 8
  s_cbranch_scc1 A_LOOP
  s_waitcnt lgkmcnt(1)
  v_mfma_f32_32x32x16_bf16 v[80:95], v[24:27], v[40:43], v[80:95]
  s_waitcnt lgkmcnt(0)
  v_mfma_f32_32x32x16_bf16 v[80:95], v[28:31], v[44:47], v[80:95]
  s_nop 11
  v_mov_b32 v112, v88
  v_mov_b32 v116, v88
  s_nop 1
  v_permlane32_swap_b32 v112, v116
  v_mov_b32 v88, v112
  s_mov_b32 s44, 0x6c800000
  v_cmp_nlt_f32 vcc, v88, s44
  v_rcp_f32 v112, v88
  s_nop 0
  v_mul_f32 v48, v80, v112
  v_mul_f32 v49, v81, v112
  v_mul_f32 v50, v82, v112
  v_mul_f32 v51, v83, v112
  v_mul_f32 v52, v84, v112
  v_mul_f32 v53, v85, v112
  v_mul_f32 v54, v86, v112
  v_mul_f32 v55, v87, v112
  v_mul_f32 v115, 0, v48
  v_fma_f32 v115, v49, 0, v115
  v_fma_f32 v115, v50, 0, v115
  v_fma_f32 v115, v51, 0, v115
  v_fma_f32 v115, v52, 0, v115
  v_fma_f32 v115, v53, 0, v115
  v_fma_f32 v115, v54, 0, v115
  v_fma_f32 v115, v55, 0, v115
  v_cmp_u_f32 s[46:47], v115, v115
  s_or_b64 vcc, vcc, s[46:47]
  s_cbranch_vccz A_STORE
  v_mov_b32 v3, 0xff800000
  s_mov_b32 s43, 0
  s_mov_b32 s45, 4194304
A_FB1:
  buffer_load_dwordx4 v[8:11], v1, s[28:31], s45 offen sc1
  s_waitcnt vmcnt(0)
  v_mfma_f32_32x32x16_bf16 v[48:63], v[8:11], v[4:7], 0
  s_nop 11
  v_max3_f32 v3, v3, v48, v49
  v_max3_f32 v3, v3, v50, v51
  v_max3_f32 v3, v3, v52, v53
  v_max3_f32 v3, v3, v54, v55
  v_max3_f32 v3, v3, v56, v57
  v_max3_f32 v3, v3, v58, v59
  v_max3_f32 v3, v3, v60, v61
  v_max3_f32 v3, v3, v62, v63
  s_add_u32 s45, s45, 2048
  s_add_u32 s43, s43, 1
  s_cmp_lt_u32 s43, 64
  s_cbranch_scc1 A_FB1
  v_mov_b32 v112, v3
  s_nop 1
  v_permlane32_swap_b32 v3, v112
  v_max_f32 v3, v3, v112
  v_sub_f32 v96, 0, v3
  v_sub_f32 v97, 0, v3
  v_sub_f32 v98, 0, v3
  v_sub_f32 v99, 0, v3
  v_sub_f32 v100, 0, v3
  v_sub_f32 v101, 0, v3
  v_sub_f32 v102, 0, v3
  v_sub_f32 v103, 0, v3
  v_sub_f32 v104, 0, v3
  v_sub_f32 v105, 0, v3
  v_sub_f32 v106, 0, v3
  v_sub_f32 v107, 0, v3
  v_sub_f32 v108, 0, v3
  v_sub_f32 v109, 0, v3
  v_sub_f32 v110, 0, v3
  v_sub_f32 v111, 0, v3
  v_mov_b32 v80, 0
  v_mov_b32 v81, 0
  v_mov_b32 v82, 0
  v_mov_b32 v83, 0
  v_mov_b32 v84, 0
  v_mov_b32 v85, 0
  v_mov_b32 v86, 0
  v_mov_b32 v87, 0
  v_mov_b32 v88, 0
  v_mov_b32 v89, 0
  v_mov_b32 v90, 0
  v_mov_b32 v91, 0
  v_mov_b32 v92, 0
  v_mov_b32 v93, 0
  v_mov_b32 v94, 0
  v_mov_b32 v95, 0
  s_mov_b32 s43, 0
  s_mov_b32 s45, 4194304
A_FB2:
  buffer_load_dwordx4 v[8:11], v1, s[28:31], s45 offen sc1
  s_mov_b64 exec, s[40:41]
  buffer_load_dwordx4 v[16:19], v2, s[28:31], s45 offen offset:1024 sc1
  buffer_load_dwordx4 v[20:23], v2, s[28:31], s45 offen offset:1536 sc1
  s_mov_b64 exec, -1
  s_waitcnt vmcnt(2)
  v_mfma_f32_32x32x16_bf16 v[48:63], v[8:11], v[4:7], v[96:111]
  s_nop 11
  v_exp_f32 v48, v48
  v_exp_f32 v49, v49
  v_exp_f32 v50, v50
  v_exp_f32 v51, v51
  v_exp_f32 v52, v52
  v_exp_f32 v53, v53
  v_exp_f32 v54, v54
  v_exp_f32 v55, v55
  v_exp_f32 v56, v56
  v_exp_f32 v57, v57
  v_exp_f32 v58, v58
  v_exp_f32 v59, v59
  v_exp_f32 v60, v60
  v_exp_f32 v61, v61
  v_exp_f32 v62, v62
  v_exp_f32 v63, v63
  v_cvt_pk_bf16_f32 v32, v48, v49
  v_cvt_pk_bf16_f32 v33, v50, v51
  v_cvt_pk_bf16_f32 v34, v52, v53
  v_cvt_pk_bf16_f32 v35, v54, v55
  v_cvt_pk_bf16_f32 v36, v56, v57
  v_cvt_pk_bf16_f32 v37, v58, v59
  v_cvt_pk_bf16_f32 v38, v60, v61
  v_cvt_pk_bf16_f32 v39, v62, v63
  s_waitcnt vmcnt(1)
  v_mfma_f32_32x32x16_bf16 v[80:95], v[16:19], v[32:35], v[80:95]
  s_waitcnt vmcnt(0)
  v_mfma_f32_32x32x16_bf16 v[80:95], v[20:23], v[36:39], v[80:95]
  s_add_u32 s45, s45, 2048
  s_add_u32 s43, s43, 1
  s_cmp_lt_u32 s43, 64
  s_cbranch_scc1 A_FB2
  s_nop 7
  v_mov_b32 v112, v88
  v_mov_b32 v116, v88
  s_nop 1
  v_permlane32_swap_b32 v112, v116
  v_mov_b32 v88, v112
  v_rcp_f32 v112, v88
  s_nop 0
  v_mul_f32 v48, v80, v112
  v_mul_f32 v49, v81, v112
  v_mul_f32 v50, v82, v112
  v_mul_f32 v51, v83, v112
  v_mul_f32 v52, v84, v112
  v_mul_f32 v53, v85, v112
  v_mul_f32 v54, v86, v112
  v_mul_f32 v55, v87, v112
A_STORE:
  v_cvt_pk_bf16_f32 v32, v48, v49
  v_cvt_pk_bf16_f32 v33, v50, v51
  v_cvt_pk_bf16_f32 v34, v52, v53
  v_cvt_pk_bf16_f32 v35, v54, v55
  s_add_u32 s39, s38, 11534336
  buffer_store_dwordx4 v[32:35], v1, s[28:31], s39 offen sc1
  s_waitcnt vmcnt(0)
  s_barrier
  s_cmp_lg_u32 s32, 0
  s_cbranch_scc1 A_DONE
  s_lshl_b32 s36, s33, 5
  s_add_u32 s36, s36, s34
  s_lshl_b32 s36, s36, 2
  s_add_u32 s36, s36, 0xf04000
  v_mov_b32 v8, s36
  v_mov_b32 v9, s80
  s_mov_b64 exec, 1
  global_store_dword v8, v9, s[14:15] sc1
  s_mov_b64 exec, -1
  s_branch A_DONE
A_B1:
  s_waitcnt vmcnt(0)
  s_barrier
  v_subrev_u32 v113, 81920, v113
  v_subrev_u32 v115, 81920, v115
  s_branch A_BODY
A_B2:
  s_barrier
  s_lshl_b32 s60, s32, 10
  s_add_u32 s60, s60, 65536
  s_mov_b32 m0, s60
  s_nop 0
  buffer_load_dwordx4 v1, s[28:31], s61 offen sc1 lds
  s_add_u32 s60, s60, 8192
  s_add_u32 s61, s61, 8192
  s_mov_b32 m0, s60
  s_nop 0
  buffer_load_dwordx4 v1, s[28:31], s61 offen sc1 lds
  s_add_u32 s60, s60, 8192
  s_add_u32 s61, s61, 8192
  s_lshl_b32 s60, s32, 10
  s_mov_b32 m0, s60
  s_nop 0
  buffer_load_dwordx4 v1, s[28:31], s61 offen sc1 lds
  s_add_u32 s60, s60, 8192
  s_add_u32 s61, s61, 8192
  s_mov_b32 m0, s60
  s_nop 0
  buffer_load_dwordx4 v1, s[28:31], s61 offen sc1 lds
  s_add_u32 s60, s60, 8192
  s_add_u32 s61, s61, 8192
  s_mov_b32 m0, s60
  s_nop 0
  buffer_load_dwordx4 v1, s[28:31], s61 offen sc1 lds
  s_add_u32 s60, s60, 8192
  s_add_u32 s61, s61, 8192
  s_mov_b32 m0, s60
  s_nop 0
  buffer_load_dwordx4 v1, s[28:31], s61 offen sc1 lds
  s_add_u32 s60, s60, 8192
  s_add_u32 s61, s61, 8192
  s_branch A_BODY
A_B3:
  s_waitcnt vmcnt(0)
  s_barrier
  s_load_dwordx2 s[52:53], s[0:1], 32
  v_lshlrev_b32 v117, 10, v0
  s_lshl_b32 s45, s32, 16
  s_lshl_b32 s46, s34, 7
  s_add_u32 s45, s45, s46
  s_waitcnt lgkmcnt(0)
  s_and_b32 s53, s53, 0xffff
  s_mov_b32 s54, 524288
  s_mov_b32 s55, 0x00020000
  buffer_load_dword v121, v117, s[52:55], s45 offen
  s_branch A_BODY
A_B4:
  v_subrev_u32 v114, 81920, v114
  s_branch A_BODY
A_B5:
  v_subrev_u32 v113, 81920, v113
  v_subrev_u32 v115, 81920, v115
  s_branch A_BODY
A_DONE:
  s_endpgm
F_START:
  s_mov_b32 s16, s8
  s_and_b32 s17, s9, 0xffff
  s_mov_b32 s18, 0x158000
  s_mov_b32 s19, 0x00020000
  s_mov_b32 s20, s10
  s_and_b32 s21, s11, 0xffff
  s_mov_b32 s22, 0x158000
  s_mov_b32 s23, 0x00020000
  s_mov_b32 s24, s12
  s_and_b32 s25, s13, 0xffff
  s_mov_b32 s26, 0x158000
  s_mov_b32 s27, 0x00020000
  s_and_b32 s40, s35, 7
  s_lshr_b32 s36, s35, 3
  s_lshr_b32 s41, s36, 4
  s_and_b32 s42, s36, 15
  s_mul_i32 s43, s42, 5
  s_add_u32 s43, s43, 6
  s_mul_i32 s37, s42, 6
  s_cmp_lt_u32 s42, 6
  s_cselect_b32 s43, s37, s43
  s_cselect_b32 s44, 6, 5
  s_lshl_b32 s37, s41, 4
  s_add_u32 s45, s40, s37
  s_lshr_b32 s37, s32, 2
  s_lshl_b32 s37, s37, 3
  s_add_u32 s37, s37, s45
  s_lshl_b32 s37, s37, 1
  s_bfe_u32 s38, s32, 0x10001
  s_add_u32 s37, s37, s38
  s_lshl_b32 s37, s37, 15
  s_and_b32 s38, s32, 1
  s_lshl_b32 s38, s38, 10
  s_add_u32 s51, s37, s38
  s_add_u32 s51, s51, 0
  s_lshl_b32 s67, s32, 10
  s_add_u32 s67, s67, 12288
  s_add_u32 s37, s32, 0
  s_cmp_ge_u32 s37, 6
  s_cselect_b32 s52, s20, s16
  s_cselect_b32 s53, s21, s17
  s_mov_b32 s54, s18
  s_mov_b32 s55, s19
  s_cselect_b32 s38, 6, 0
  s_cselect_b32 s39, 6144, 0
  s_cselect_b32 s60, 5, 0
  s_sub_u32 s37, s37, s38
  s_lshl_b32 s38, s37, 10
  s_add_u32 s64, s39, s38
  s_lshl_b32 s37, s37, 6
  v_add_u32 v5, s37, v0
  v_mul_u32_u24 v6, 5462, v5
  v_lshrrev_b32 v6, 16, v6
  v_mul_u32_u24 v7, 12, v6
  v_sub_u32 v5, v5, v7
  v_lshrrev_b32 v7, 1, v5
  v_add_u32 v7, s60, v7
  v_subrev_u32 v8, 6, v7
  v_cmp_gt_u32 vcc, 6, v7
  s_nop 1
  v_cndmask_b32 v7, v8, v7, vcc
  v_and_b32 v5, 1, v5
  v_lshl_add_u32 v5, v7, 1, v5
  v_mul_u32_u24 v6, 2752, v6
  v_lshl_add_u32 v5, v5, 4, v6
  s_lshl_b32 s37, s43, 5
  v_add_u32 v2, s37, v5
  s_add_u32 s37, s32, 8
  s_cmp_ge_u32 s37, 6
  s_cselect_b32 s56, s20, s16
  s_cselect_b32 s57, s21, s17
  s_mov_b32 s58, s18
  s_mov_b32 s59, s19
  s_cselect_b32 s38, 6, 0
  s_cselect_b32 s39, 6144, 0
  s_cselect_b32 s60, 5, 0
  s_sub_u32 s37, s37, s38
  s_lshl_b32 s38, s37, 10
  s_add_u32 s65, s39, s38
  s_lshl_b32 s37, s37, 6
  v_add_u32 v5, s37, v0
  v_mul_u32_u24 v6, 5462, v5
  v_lshrrev_b32 v6, 16, v6
  v_mul_u32_u24 v7, 12, v6
  v_sub_u32 v5, v5, v7
  v_lshrrev_b32 v7, 1, v5
  v_add_u32 v7, s60, v7
  v_subrev_u32 v8, 6, v7
  v_cmp_gt_u32 vcc, 6, v7
  s_nop 1
  v_cndmask_b32 v7, v8, v7, vcc
  v_and_b32 v5, 1, v5
  v_lshl_add_u32 v5, v7, 1, v5
  v_mul_u32_u24 v6, 2752, v6
  v_lshl_add_u32 v5, v5, 4, v6
  s_lshl_b32 s37, s43, 5
  v_add_u32 v3, s37, v5
  s_cmp_lg_u32 s32, 0
  s_cbranch_scc1 F_NON0
  global_load_dword v126, v127, s[82:83] sc1
  s_mov_b32 s39, 65536
  s_waitcnt vmcnt(0)
NON4:
  v_readfirstlane_b32 s80, v126
  s_cmp_lg_u32 s80, 0
  s_cbranch_scc1 NON4_OK
  s_sleep 1
  global_load_dword v126, v127, s[82:83] sc1
  s_waitcnt vmcnt(0)
  s_sub_u32 s39, s39, 1
  s_cmp_lg_u32 s39, 0
  s_cbranch_scc1 NON4
NON4_OK:
F_NON0:
  s_barrier
  s_mov_b32 s50, 0
  s_add_u32 s37, s64, 0
  s_mov_b32 m0, s37
  s_nop 0
  buffer_load_dwordx4 v2, s[52:55], s50 offen lds
  s_mov_b32 s50, 88064
  s_add_u32 s37, s64, 20480
  s_mov_b32 m0, s37
  s_nop 0
  buffer_load_dwordx4 v2, s[52:55], s50 offen lds
  s_mov_b32 s50, 176128
  s_add_u32 s37, s64, 40960
  s_mov_b32 m0, s37
  s_nop 0
  buffer_load_dwordx4 v2, s[52:55], s50 offen lds
  s_cmp_ge_u32 s32, 4
  s_cbranch_scc1 F_SKI
  s_mov_b32 s50, 0
  s_add_u32 s37, s65, 0
  s_mov_b32 m0, s37
  s_nop 0
  buffer_load_dwordx4 v3, s[56:59], s50 offen lds
  s_mov_b32 s50, 88064
  s_add_u32 s37, s65, 20480
  s_mov_b32 m0, s37
  s_nop 0
  buffer_load_dwordx4 v3, s[56:59], s50 offen lds
  s_mov_b32 s50, 176128
  s_add_u32 s37, s65, 40960
  s_mov_b32 m0, s37
  s_nop 0
  buffer_load_dwordx4 v3, s[56:59], s50 offen lds
F_SKI:
  v_bfe_u32 v8, v0, 4, 1
  v_lshrrev_b32 v9, 5, v0
  v_bfe_u32 v10, v0, 2, 2
  v_and_b32 v11, 3, v0
  v_lshl_add_u32 v12, v9, 3, v10
  v_mul_u32_u24 v12, 192, v12
  v_lshl_add_u32 v12, v11, 3, v12
  v_mul_u32_u24 v13, 6144, v8
  v_add_u32 v12, v12, v13
  s_lshr_b32 s47, s32, 2
  s_mul_i32 s37, s47, 3
  s_add_u32 s38, s37, 0
  v_add_u32 v13, s38, v8
  v_cmp_eq_u32 vcc, 6, v13
  s_nop 1
  v_cndmask_b32_e64 v13, v13, 0, vcc
  v_lshl_add_u32 v100, v13, 5, v12
  s_add_u32 s38, s37, 1
  v_add_u32 v13, s38, v8
  v_cmp_eq_u32 vcc, 6, v13
  s_nop 1
  v_cndmask_b32_e64 v13, v13, 0, vcc
  v_lshl_add_u32 v101, v13, 5, v12
  s_add_u32 s38, s37, 2
  v_add_u32 v13, s38, v8
  v_cmp_eq_u32 vcc, 6, v13
  s_nop 1
  v_cndmask_b32_e64 v13, v13, 0, vcc
  v_lshl_add_u32 v102, v13, 5, v12
  s_and_b32 s37, s32, 3
  s_lshl_b32 s38, s37, 11
  s_add_u32 s38, s38, 12288
  v_add_u32 v13, s38, v1
  s_lshr_b32 s38, s37, 1
  s_lshl_b32 s38, s38, 3
  s_add_u32 s38, s38, s45
  s_lshl_b32 s38, s38, 1
  s_and_b32 s37, s37, 1
  s_add_u32 s46, s38, s37
  s_mul_i32 s63, s47, 3
  s_add_u32 s63, s63, 2
  s_cmp_ge_u32 s63, s44
  s_cselect_b32 s63, 1, 0
  v_mov_b32 v16, 0
  v_mov_b32 v17, 0
  v_mov_b32 v18, 0
  v_mov_b32 v19, 0
  v_mov_b32 v20, 0
  v_mov_b32 v21, 0
  v_mov_b32 v22, 0
  v_mov_b32 v23, 0
  v_mov_b32 v24, 0
  v_mov_b32 v25, 0
  v_mov_b32 v26, 0
  v_mov_b32 v27, 0
  v_mov_b32 v28, 0
  v_mov_b32 v29, 0
  v_mov_b32 v30, 0
  v_mov_b32 v31, 0
  v_mov_b32 v32, 0
  v_mov_b32 v33, 0
  v_mov_b32 v34, 0
  v_mov_b32 v35, 0
  v_mov_b32 v36, 0
  v_mov_b32 v37, 0
  v_mov_b32 v38, 0
  v_mov_b32 v39, 0
  v_mov_b32 v40, 0
  v_mov_b32 v41, 0
  v_mov_b32 v42, 0
  v_mov_b32 v43, 0
  v_mov_b32 v44, 0
  v_mov_b32 v45, 0
  v_mov_b32 v46, 0
  v_mov_b32 v47, 0
  v_mov_b32 v48, 0
  v_mov_b32 v49, 0
  v_mov_b32 v50, 0
  v_mov_b32 v51, 0
  v_mov_b32 v52, 0
  v_mov_b32 v53, 0
  v_mov_b32 v54, 0
  v_mov_b32 v55, 0
  v_mov_b32 v56, 0
  v_mov_b32 v57, 0
  v_mov_b32 v58, 0
  v_mov_b32 v59, 0
  v_mov_b32 v60, 0
  v_mov_b32 v61, 0
  v_mov_b32 v62, 0
  v_mov_b32 v63, 0
  s_cmp_lg_u32 s32, 0
  s_cbranch_scc1 F_NOXW
  v_and_b32 v5, 7, v0
  v_lshrrev_b32 v6, 3, v0
  v_lshlrev_b32 v6, 3, v6
  v_add_u32 v6, s45, v6
  v_lshl_add_u32 v5, v6, 5, v5
  v_lshlrev_b32 v5, 2, v5
  v_add_u32 v5, 0xf01000, v5
  s_mov_b32 s39, 65536
  s_mov_b64 exec, 0xffff
FW5:
  global_load_dword v6, v5, s[14:15] sc1
FW5_C:
  s_waitcnt vmcnt(0)
  v_cmp_ne_u32 vcc, s80, v6
  s_nop 4
  s_cbranch_vccz FW5_OK
  s_sleep 4
  s_sub_u32 s39, s39, 1
  s_cmp_lg_u32 s39, 0
  s_cbranch_scc1 FW5
FW5_OK:
  s_mov_b64 exec, -1
F_NOXW:
  s_barrier
  s_add_u32 s37, s67, 0
  s_mov_b32 m0, s37
  s_nop 0
  buffer_load_dwordx4 v1, s[28:31], s51 offen sc1 lds
  s_add_u32 s51, s51, 2048
  s_add_u32 s37, s67, 20480
  s_mov_b32 m0, s37
  s_nop 0
  buffer_load_dwordx4 v1, s[28:31], s51 offen sc1 lds
  s_add_u32 s51, s51, 2048
  s_add_u32 s37, s67, 40960
  s_mov_b32 m0, s37
  s_nop 0
  buffer_load_dwordx4 v1, s[28:31], s51 offen sc1 lds
  s_add_u32 s51, s51, 2048
  s_mov_b32 s50, 264192
  s_setprio 1
  s_waitcnt vmcnt(0)
  s_mov_b32 s61, 3
F_L1:
  s_waitcnt vmcnt(4)
  s_barrier
  s_add_u32 s37, s64, 61440
  s_mov_b32 m0, s37
  s_nop 0
  buffer_load_dwordx4 v2, s[52:55], s50 offen lds
  s_add_u32 s37, s67, 61440
  s_mov_b32 m0, s37
  s_nop 0
  buffer_load_dwordx4 v1, s[28:31], s51 offen sc1 lds
  s_add_u32 s51, s51, 2048
  s_cmp_ge_u32 s32, 4
  s_cbranch_scc1 F_SK6
  s_add_u32 s37, s65, 61440
  s_mov_b32 m0, s37
  s_nop 0
  buffer_load_dwordx4 v3, s[56:59], s50 offen lds
F_SK6:
  s_add_u32 s50, s50, 88064
  ds_read_b128 v[88:91], v13 offset:0
  ds_read_b128 v[92:95], v13 offset:1024
  ds_read_b64_tr_b16 v[64:65], v100 offset:0
  ds_read_b64_tr_b16 v[66:67], v100 offset:768
  s_waitcnt lgkmcnt(0)
  v_mfma_f32_32x32x16_bf16 v[16:31], v[64:67], v[88:91], v[16:31]
  ds_read_b64_tr_b16 v[68:69], v101 offset:0
  ds_read_b64_tr_b16 v[70:71], v101 offset:768
  s_waitcnt lgkmcnt(0)
  v_mfma_f32_32x32x16_bf16 v[32:47], v[68:71], v[88:91], v[32:47]
  s_cmp_eq_u32 s63, 1
  s_cbranch_scc1 F_G7
  ds_read_b64_tr_b16 v[72:73], v102 offset:0
  ds_read_b64_tr_b16 v[74:75], v102 offset:768
  s_waitcnt lgkmcnt(0)
  v_mfma_f32_32x32x16_bf16 v[48:63], v[72:75], v[88:91], v[48:63]
F_G7:
  ds_read_b64_tr_b16 v[76:77], v100 offset:3072
  ds_read_b64_tr_b16 v[78:79], v100 offset:3840
  s_waitcnt lgkmcnt(0)
  v_mfma_f32_32x32x16_bf16 v[16:31], v[76:79], v[92:95], v[16:31]
  ds_read_b64_tr_b16 v[80:81], v101 offset:3072
  ds_read_b64_tr_b16 v[82:83], v101 offset:3840
  s_waitcnt lgkmcnt(0)
  v_mfma_f32_32x32x16_bf16 v[32:47], v[80:83], v[92:95], v[32:47]
  s_cmp_eq_u32 s63, 1
  s_cbranch_scc1 F_G8
  ds_read_b64_tr_b16 v[84:85], v102 offset:3072
  ds_read_b64_tr_b16 v[86:87], v102 offset:3840
  s_waitcnt lgkmcnt(0)
  v_mfma_f32_32x32x16_bf16 v[48:63], v[84:87], v[92:95], v[48:63]
F_G8:
  s_waitcnt vmcnt(4)
  s_barrier
  s_add_u32 s37, s64, 0
  s_mov_b32 m0, s37
  s_nop 0
  buffer_load_dwordx4 v2, s[52:55], s50 offen lds
  s_add_u32 s37, s67, 0
  s_mov_b32 m0, s37
  s_nop 0
  buffer_load_dwordx4 v1, s[28:31], s51 offen sc1 lds
  s_add_u32 s51, s51, 2048
  s_cmp_ge_u32 s32, 4
  s_cbranch_scc1 F_SK9
  s_add_u32 s37, s65, 0
  s_mov_b32 m0, s37
  s_nop 0
  buffer_load_dwordx4 v3, s[56:59], s50 offen lds
F_SK9:
  s_add_u32 s50, s50, 88064
  ds_read_b128 v[88:91], v13 offset:20480
  ds_read_b128 v[92:95], v13 offset:21504
  ds_read_b64_tr_b16 v[64:65], v100 offset:20480
  ds_read_b64_tr_b16 v[66:67], v100 offset:21248
  s_waitcnt lgkmcnt(0)
  v_mfma_f32_32x32x16_bf16 v[16:31], v[64:67], v[88:91], v[16:31]
  ds_read_b64_tr_b16 v[68:69], v101 offset:20480
  ds_read_b64_tr_b16 v[70:71], v101 offset:21248
  s_waitcnt lgkmcnt(0)
  v_mfma_f32_32x32x16_bf16 v[32:47], v[68:71], v[88:91], v[32:47]
  s_cmp_eq_u32 s63, 1
  s_cbranch_scc1 F_G10
  ds_read_b64_tr_b16 v[72:73], v102 offset:20480
  ds_read_b64_tr_b16 v[74:75], v102 offset:21248
  s_waitcnt lgkmcnt(0)
  v_mfma_f32_32x32x16_bf16 v[48:63], v[72:75], v[88:91], v[48:63]
F_G10:
  ds_read_b64_tr_b16 v[76:77], v100 offset:23552
  ds_read_b64_tr_b16 v[78:79], v100 offset:24320
  s_waitcnt lgkmcnt(0)
  v_mfma_f32_32x32x16_bf16 v[16:31], v[76:79], v[92:95], v[16:31]
  ds_read_b64_tr_b16 v[80:81], v101 offset:23552
  ds_read_b64_tr_b16 v[82:83], v101 offset:24320
  s_waitcnt lgkmcnt(0)
  v_mfma_f32_32x32x16_bf16 v[32:47], v[80:83], v[92:95], v[32:47]
  s_cmp_eq_u32 s63, 1
  s_cbranch_scc1 F_G11
  ds_read_b64_tr_b16 v[84:85], v102 offset:23552
  ds_read_b64_tr_b16 v[86:87], v102 offset:24320
  s_waitcnt lgkmcnt(0)
  v_mfma_f32_32x32x16_bf16 v[48:63], v[84:87], v[92:95], v[48:63]
F_G11:
  s_waitcnt vmcnt(4)
  s_barrier
  s_add_u32 s37, s64, 20480
  s_mov_b32 m0, s37
  s_nop 0
  buffer_load_dwordx4 v2, s[52:55], s50 offen lds
  s_add_u32 s37, s67, 20480
  s_mov_b32 m0, s37
  s_nop 0
  buffer_load_dwordx4 v1, s[28:31], s51 offen sc1 lds
  s_add_u32 s51, s51, 2048
  s_cmp_ge_u32 s32, 4
  s_cbranch_scc1 F_SK12
  s_add_u32 s37, s65, 20480
  s_mov_b32 m0, s37
  s_nop 0
  buffer_load_dwordx4 v3, s[56:59], s50 offen lds
F_SK12:
  s_add_u32 s50, s50, 88064
  ds_read_b128 v[88:91], v13 offset:40960
  ds_read_b128 v[92:95], v13 offset:41984
  ds_read_b64_tr_b16 v[64:65], v100 offset:40960
  ds_read_b64_tr_b16 v[66:67], v100 offset:41728
  s_waitcnt lgkmcnt(0)
  v_mfma_f32_32x32x16_bf16 v[16:31], v[64:67], v[88:91], v[16:31]
  ds_read_b64_tr_b16 v[68:69], v101 offset:40960
  ds_read_b64_tr_b16 v[70:71], v101 offset:41728
  s_waitcnt lgkmcnt(0)
  v_mfma_f32_32x32x16_bf16 v[32:47], v[68:71], v[88:91], v[32:47]
  s_cmp_eq_u32 s63, 1
  s_cbranch_scc1 F_G13
  ds_read_b64_tr_b16 v[72:73], v102 offset:40960
  ds_read_b64_tr_b16 v[74:75], v102 offset:41728
  s_waitcnt lgkmcnt(0)
  v_mfma_f32_32x32x16_bf16 v[48:63], v[72:75], v[88:91], v[48:63]
F_G13:
  ds_read_b64_tr_b16 v[76:77], v100 offset:44032
  ds_read_b64_tr_b16 v[78:79], v100 offset:44800
  s_waitcnt lgkmcnt(0)
  v_mfma_f32_32x32x16_bf16 v[16:31], v[76:79], v[92:95], v[16:31]
  ds_read_b64_tr_b16 v[80:81], v101 offset:44032
  ds_read_b64_tr_b16 v[82:83], v101 offset:44800
  s_waitcnt lgkmcnt(0)
  v_mfma_f32_32x32x16_bf16 v[32:47], v[80:83], v[92:95], v[32:47]
  s_cmp_eq_u32 s63, 1
  s_cbranch_scc1 F_G14
  ds_read_b64_tr_b16 v[84:85], v102 offset:44032
  ds_read_b64_tr_b16 v[86:87], v102 offset:44800
  s_waitcnt lgkmcnt(0)
  v_mfma_f32_32x32x16_bf16 v[48:63], v[84:87], v[92:95], v[48:63]
F_G14:
  s_waitcnt vmcnt(4)
  s_barrier
  s_add_u32 s37, s64, 40960
  s_mov_b32 m0, s37
  s_nop 0
  buffer_load_dwordx4 v2, s[52:55], s50 offen lds
  s_add_u32 s37, s67, 40960
  s_mov_b32 m0, s37
  s_nop 0
  buffer_load_dwordx4 v1, s[28:31], s51 offen sc1 lds
  s_add_u32 s51, s51, 2048
  s_cmp_ge_u32 s32, 4
  s_cbranch_scc1 F_SK15
  s_add_u32 s37, s65, 40960
  s_mov_b32 m0, s37
  s_nop 0
  buffer_load_dwordx4 v3, s[56:59], s50 offen lds
F_SK15:
  s_add_u32 s50, s50, 88064
  ds_read_b128 v[88:91], v13 offset:61440
  ds_read_b128 v[92:95], v13 offset:62464
  ds_read_b64_tr_b16 v[64:65], v100 offset:61440
  ds_read_b64_tr_b16 v[66:67], v100 offset:62208
  s_waitcnt lgkmcnt(0)
  v_mfma_f32_32x32x16_bf16 v[16:31], v[64:67], v[88:91], v[16:31]
  ds_read_b64_tr_b16 v[68:69], v101 offset:61440
  ds_read_b64_tr_b16 v[70:71], v101 offset:62208
  s_waitcnt lgkmcnt(0)
  v_mfma_f32_32x32x16_bf16 v[32:47], v[68:71], v[88:91], v[32:47]
  s_cmp_eq_u32 s63, 1
  s_cbranch_scc1 F_G16
  ds_read_b64_tr_b16 v[72:73], v102 offset:61440
  ds_read_b64_tr_b16 v[74:75], v102 offset:62208
  s_waitcnt lgkmcnt(0)
  v_mfma_f32_32x32x16_bf16 v[48:63], v[72:75], v[88:91], v[48:63]
F_G16:
  ds_read_b64_tr_b16 v[76:77], v100 offset:64512
  ds_read_b64_tr_b16 v[78:79], v100 offset:65280
  s_waitcnt lgkmcnt(0)
  v_mfma_f32_32x32x16_bf16 v[16:31], v[76:79], v[92:95], v[16:31]
  ds_read_b64_tr_b16 v[80:81], v101 offset:64512
  ds_read_b64_tr_b16 v[82:83], v101 offset:65280
  s_waitcnt lgkmcnt(0)
  v_mfma_f32_32x32x16_bf16 v[32:47], v[80:83], v[92:95], v[32:47]
  s_cmp_eq_u32 s63, 1
  s_cbranch_scc1 F_G17
  ds_read_b64_tr_b16 v[84:85], v102 offset:64512
  ds_read_b64_tr_b16 v[86:87], v102 offset:65280
  s_waitcnt lgkmcnt(0)
  v_mfma_f32_32x32x16_bf16 v[48:63], v[84:87], v[92:95], v[48:63]
F_G17:
  s_sub_u32 s61, s61, 1
  s_cmp_lg_u32 s61, 0
  s_cbranch_scc1 F_L1
  s_waitcnt vmcnt(4)
  s_barrier
  s_add_u32 s37, s64, 61440
  s_mov_b32 m0, s37
  s_nop 0
  buffer_load_dwordx4 v2, s[52:55], s50 offen lds
  s_add_u32 s37, s67, 61440
  s_mov_b32 m0, s37
  s_nop 0
  buffer_load_dwordx4 v1, s[28:31], s51 offen sc1 lds
  s_add_u32 s51, s51, 2048
  s_cmp_ge_u32 s32, 4
  s_cbranch_scc1 F_SK18
  s_add_u32 s37, s65, 61440
  s_mov_b32 m0, s37
  s_nop 0
  buffer_load_dwordx4 v3, s[56:59], s50 offen lds
F_SK18:
  s_add_u32 s50, s50, 88064
  ds_read_b128 v[88:91], v13 offset:0
  ds_read_b128 v[92:95], v13 offset:1024
  ds_read_b64_tr_b16 v[64:65], v100 offset:0
  ds_read_b64_tr_b16 v[66:67], v100 offset:768
  s_waitcnt lgkmcnt(0)
  v_mfma_f32_32x32x16_bf16 v[16:31], v[64:67], v[88:91], v[16:31]
  ds_read_b64_tr_b16 v[68:69], v101 offset:0
  ds_read_b64_tr_b16 v[70:71], v101 offset:768
  s_waitcnt lgkmcnt(0)
  v_mfma_f32_32x32x16_bf16 v[32:47], v[68:71], v[88:91], v[32:47]
  s_cmp_eq_u32 s63, 1
  s_cbranch_scc1 F_G19
  ds_read_b64_tr_b16 v[72:73], v102 offset:0
  ds_read_b64_tr_b16 v[74:75], v102 offset:768
  s_waitcnt lgkmcnt(0)
  v_mfma_f32_32x32x16_bf16 v[48:63], v[72:75], v[88:91], v[48:63]
F_G19:
  ds_read_b64_tr_b16 v[76:77], v100 offset:3072
  ds_read_b64_tr_b16 v[78:79], v100 offset:3840
  s_waitcnt lgkmcnt(0)
  v_mfma_f32_32x32x16_bf16 v[16:31], v[76:79], v[92:95], v[16:31]
  ds_read_b64_tr_b16 v[80:81], v101 offset:3072
  ds_read_b64_tr_b16 v[82:83], v101 offset:3840
  s_waitcnt lgkmcnt(0)
  v_mfma_f32_32x32x16_bf16 v[32:47], v[80:83], v[92:95], v[32:47]
  s_cmp_eq_u32 s63, 1
  s_cbranch_scc1 F_G20
  ds_read_b64_tr_b16 v[84:85], v102 offset:3072
  ds_read_b64_tr_b16 v[86:87], v102 offset:3840
  s_waitcnt lgkmcnt(0)
  v_mfma_f32_32x32x16_bf16 v[48:63], v[84:87], v[92:95], v[48:63]
F_G20:
  s_waitcnt vmcnt(4)
  s_barrier
  ds_read_b128 v[88:91], v13 offset:20480
  ds_read_b128 v[92:95], v13 offset:21504
  ds_read_b64_tr_b16 v[64:65], v100 offset:20480
  ds_read_b64_tr_b16 v[66:67], v100 offset:21248
  s_waitcnt lgkmcnt(0)
  v_mfma_f32_32x32x16_bf16 v[16:31], v[64:67], v[88:91], v[16:31]
  ds_read_b64_tr_b16 v[68:69], v101 offset:20480
  ds_read_b64_tr_b16 v[70:71], v101 offset:21248
  s_waitcnt lgkmcnt(0)
  v_mfma_f32_32x32x16_bf16 v[32:47], v[68:71], v[88:91], v[32:47]
  s_cmp_eq_u32 s63, 1
  s_cbranch_scc1 F_G21
  ds_read_b64_tr_b16 v[72:73], v102 offset:20480
  ds_read_b64_tr_b16 v[74:75], v102 offset:21248
  s_waitcnt lgkmcnt(0)
  v_mfma_f32_32x32x16_bf16 v[48:63], v[72:75], v[88:91], v[48:63]
F_G21:
  ds_read_b64_tr_b16 v[76:77], v100 offset:23552
  ds_read_b64_tr_b16 v[78:79], v100 offset:24320
  s_waitcnt lgkmcnt(0)
  v_mfma_f32_32x32x16_bf16 v[16:31], v[76:79], v[92:95], v[16:31]
  ds_read_b64_tr_b16 v[80:81], v101 offset:23552
  ds_read_b64_tr_b16 v[82:83], v101 offset:24320
  s_waitcnt lgkmcnt(0)
  v_mfma_f32_32x32x16_bf16 v[32:47], v[80:83], v[92:95], v[32:47]
  s_cmp_eq_u32 s63, 1
  s_cbranch_scc1 F_G22
  ds_read_b64_tr_b16 v[84:85], v102 offset:23552
  ds_read_b64_tr_b16 v[86:87], v102 offset:24320
  s_waitcnt lgkmcnt(0)
  v_mfma_f32_32x32x16_bf16 v[48:63], v[84:87], v[92:95], v[48:63]
F_G22:
  s_waitcnt vmcnt(2)
  s_barrier
  ds_read_b128 v[88:91], v13 offset:40960
  ds_read_b128 v[92:95], v13 offset:41984
  ds_read_b64_tr_b16 v[64:65], v100 offset:40960
  ds_read_b64_tr_b16 v[66:67], v100 offset:41728
  s_waitcnt lgkmcnt(0)
  v_mfma_f32_32x32x16_bf16 v[16:31], v[64:67], v[88:91], v[16:31]
  ds_read_b64_tr_b16 v[68:69], v101 offset:40960
  ds_read_b64_tr_b16 v[70:71], v101 offset:41728
  s_waitcnt lgkmcnt(0)
  v_mfma_f32_32x32x16_bf16 v[32:47], v[68:71], v[88:91], v[32:47]
  s_cmp_eq_u32 s63, 1
  s_cbranch_scc1 F_G23
  ds_read_b64_tr_b16 v[72:73], v102 offset:40960
  ds_read_b64_tr_b16 v[74:75], v102 offset:41728
  s_waitcnt lgkmcnt(0)
  v_mfma_f32_32x32x16_bf16 v[48:63], v[72:75], v[88:91], v[48:63]
F_G23:
  ds_read_b64_tr_b16 v[76:77], v100 offset:44032
  ds_read_b64_tr_b16 v[78:79], v100 offset:44800
  s_waitcnt lgkmcnt(0)
  v_mfma_f32_32x32x16_bf16 v[16:31], v[76:79], v[92:95], v[16:31]
  ds_read_b64_tr_b16 v[80:81], v101 offset:44032
  ds_read_b64_tr_b16 v[82:83], v101 offset:44800
  s_waitcnt lgkmcnt(0)
  v_mfma_f32_32x32x16_bf16 v[32:47], v[80:83], v[92:95], v[32:47]
  s_cmp_eq_u32 s63, 1
  s_cbranch_scc1 F_G24
  ds_read_b64_tr_b16 v[84:85], v102 offset:44032
  ds_read_b64_tr_b16 v[86:87], v102 offset:44800
  s_waitcnt lgkmcnt(0)
  v_mfma_f32_32x32x16_bf16 v[48:63], v[84:87], v[92:95], v[48:63]
F_G24:
  s_waitcnt vmcnt(0)
  s_barrier
  ds_read_b128 v[88:91], v13 offset:61440
  ds_read_b128 v[92:95], v13 offset:62464
  ds_read_b64_tr_b16 v[64:65], v100 offset:61440
  ds_read_b64_tr_b16 v[66:67], v100 offset:62208
  s_waitcnt lgkmcnt(0)
  v_mfma_f32_32x32x16_bf16 v[16:31], v[64:67], v[88:91], v[16:31]
  ds_read_b64_tr_b16 v[68:69], v101 offset:61440
  ds_read_b64_tr_b16 v[70:71], v101 offset:62208
  s_waitcnt lgkmcnt(0)
  v_mfma_f32_32x32x16_bf16 v[32:47], v[68:71], v[88:91], v[32:47]
  s_cmp_eq_u32 s63, 1
  s_cbranch_scc1 F_G25
  ds_read_b64_tr_b16 v[72:73], v102 offset:61440
  ds_read_b64_tr_b16 v[74:75], v102 offset:62208
  s_waitcnt lgkmcnt(0)
  v_mfma_f32_32x32x16_bf16 v[48:63], v[72:75], v[88:91], v[48:63]
F_G25:
  ds_read_b64_tr_b16 v[76:77], v100 offset:64512
  ds_read_b64_tr_b16 v[78:79], v100 offset:65280
  s_waitcnt lgkmcnt(0)
  v_mfma_f32_32x32x16_bf16 v[16:31], v[76:79], v[92:95], v[16:31]
  ds_read_b64_tr_b16 v[80:81], v101 offset:64512
  ds_read_b64_tr_b16 v[82:83], v101 offset:65280
  s_waitcnt lgkmcnt(0)
  v_mfma_f32_32x32x16_bf16 v[32:47], v[80:83], v[92:95], v[32:47]
  s_cmp_eq_u32 s63, 1
  s_cbranch_scc1 F_G26
  ds_read_b64_tr_b16 v[84:85], v102 offset:64512
  ds_read_b64_tr_b16 v[86:87], v102 offset:65280
  s_waitcnt lgkmcnt(0)
  v_mfma_f32_32x32x16_bf16 v[48:63], v[84:87], v[92:95], v[48:63]
F_G26:
  s_barrier
  s_lshl_b32 s36, s41, 1
  s_lshr_b32 s37, s42, 3
  s_add_u32 s36, s36, s37
  s_lshl_b32 s36, s36, 3
  s_add_u32 s48, s36, s40
  s_and_b32 s49, s42, 7
  v_lshrrev_b32 v2, 3, v0
  v_and_b32 v3, 7, v0
  v_bfe_u32 v4, v2, 1, 1
  v_lshlrev_b32 v4, 2, v4
  v_xor_b32 v3, v3, v4
  v_lshlrev_b32 v3, 4, v3
  v_lshl_add_u32 v2, v2, 10, v3
  s_lshl_b32 s36, s32, 13
  s_lshl_b32 s37, s49, 7
  s_add_u32 s52, s36, s37
  s_lshl_b32 s53, s32, 10
  s_lshr_b32 s36, s32, 2
  s_lshl_b32 s37, s48, 1
  s_add_u32 s36, s36, s37
  s_mul_i32 s54, s36, 86
  s_and_b32 s37, s32, 3
  s_add_u32 s54, s54, s37
  s_lshl_b32 s54, s54, 10
  s_add_u32 s54, s54, 0x500000
  s_add_u32 s55, s53, 8192
  s_add_u32 s36, s53, 0
  s_mov_b32 m0, s36
  s_nop 0
  buffer_load_dwordx4 v2, s[24:27], s52 offen lds
  s_add_u32 s52, s52, 65536
  s_add_u32 s36, s53, 16384
  s_mov_b32 m0, s36
  s_nop 0
  buffer_load_dwordx4 v2, s[24:27], s52 offen lds
  s_add_u32 s52, s52, 65536
  s_add_u32 s36, s53, 32768
  s_mov_b32 m0, s36
  s_nop 0
  buffer_load_dwordx4 v2, s[24:27], s52 offen lds
  s_add_u32 s52, s52, 65536
  s_setprio 3
  s_mov_b32 s38, 0xbfb8aa3b
  s_mov_b32 s39, 0xbfb8aa3b
  s_mul_i32 s37, s46, 86
  s_add_u32 s37, s37, s43
  s_mul_i32 s62, s47, 3
  s_add_u32 s37, s37, s62
  s_lshl_b32 s37, s37, 10
  s_add_u32 s37, s37, 0x500000
  v_pk_mul_f32 v[64:65], v[16:17], s[38:39]
  v_pk_mul_f32 v[66:67], v[18:19], s[38:39]
  v_pk_mul_f32 v[68:69], v[20:21], s[38:39]
  v_pk_mul_f32 v[70:71], v[22:23], s[38:39]
  v_exp_f32 v64, v64
  v_exp_f32 v65, v65
  v_exp_f32 v66, v66
  v_exp_f32 v67, v67
  v_exp_f32 v68, v68
  v_exp_f32 v69, v69
  v_exp_f32 v70, v70
  v_exp_f32 v71, v71
  v_pk_mul_f32 v[16:17], v[16:17], v[24:25]
  v_pk_mul_f32 v[18:19], v[18:19], v[26:27]
  v_pk_mul_f32 v[20:21], v[20:21], v[28:29]
  v_pk_mul_f32 v[22:23], v[22:23], v[30:31]
  v_pk_add_f32 v[64:65], v[64:65], 1.0 op_sel_hi:[1,0]
  v_pk_add_f32 v[66:67], v[66:67], 1.0 op_sel_hi:[1,0]
  v_pk_add_f32 v[68:69], v[68:69], 1.0 op_sel_hi:[1,0]
  v_pk_add_f32 v[70:71], v[70:71], 1.0 op_sel_hi:[1,0]
  v_rcp_f32 v64, v64
  v_rcp_f32 v65, v65
  v_rcp_f32 v66, v66
  v_rcp_f32 v67, v67
  v_rcp_f32 v68, v68
  v_rcp_f32 v69, v69
  v_rcp_f32 v70, v70
  v_rcp_f32 v71, v71
  v_pk_mul_f32 v[16:17], v[16:17], v[64:65]
  v_pk_mul_f32 v[18:19], v[18:19], v[66:67]
  v_pk_mul_f32 v[20:21], v[20:21], v[68:69]
  v_pk_mul_f32 v[22:23], v[22:23], v[70:71]
  v_cvt_pk_bf16_f32 v72, v16, v17
  v_cvt_pk_bf16_f32 v73, v18, v19
  v_cvt_pk_bf16_f32 v74, v20, v21
  v_cvt_pk_bf16_f32 v75, v22, v23
  buffer_store_dwordx4 v[72:75], v1, s[28:31], s37 offen offset:0 sc1
  v_pk_mul_f32 v[64:65], v[32:33], s[38:39]
  v_pk_mul_f32 v[66:67], v[34:35], s[38:39]
  v_pk_mul_f32 v[68:69], v[36:37], s[38:39]
  v_pk_mul_f32 v[70:71], v[38:39], s[38:39]
  v_exp_f32 v64, v64
  v_exp_f32 v65, v65
  v_exp_f32 v66, v66
  v_exp_f32 v67, v67
  v_exp_f32 v68, v68
  v_exp_f32 v69, v69
  v_exp_f32 v70, v70
  v_exp_f32 v71, v71
  v_pk_mul_f32 v[32:33], v[32:33], v[40:41]
  v_pk_mul_f32 v[34:35], v[34:35], v[42:43]
  v_pk_mul_f32 v[36:37], v[36:37], v[44:45]
  v_pk_mul_f32 v[38:39], v[38:39], v[46:47]
  v_pk_add_f32 v[64:65], v[64:65], 1.0 op_sel_hi:[1,0]
  v_pk_add_f32 v[66:67], v[66:67], 1.0 op_sel_hi:[1,0]
  v_pk_add_f32 v[68:69], v[68:69], 1.0 op_sel_hi:[1,0]
  v_pk_add_f32 v[70:71], v[70:71], 1.0 op_sel_hi:[1,0]
  v_rcp_f32 v64, v64
  v_rcp_f32 v65, v65
  v_rcp_f32 v66, v66
  v_rcp_f32 v67, v67
  v_rcp_f32 v68, v68
  v_rcp_f32 v69, v69
  v_rcp_f32 v70, v70
  v_rcp_f32 v71, v71
  v_pk_mul_f32 v[32:33], v[32:33], v[64:65]
  v_pk_mul_f32 v[34:35], v[34:35], v[66:67]
  v_pk_mul_f32 v[36:37], v[36:37], v[68:69]
  v_pk_mul_f32 v[38:39], v[38:39], v[70:71]
  v_cvt_pk_bf16_f32 v76, v32, v33
  v_cvt_pk_bf16_f32 v77, v34, v35
  v_cvt_pk_bf16_f32 v78, v36, v37
  v_cvt_pk_bf16_f32 v79, v38, v39
  buffer_store_dwordx4 v[76:79], v1, s[28:31], s37 offen offset:1024 sc1
  s_cmp_eq_u32 s63, 1
  s_cbranch_scc1 F_HDONE
  v_pk_mul_f32 v[64:65], v[48:49], s[38:39]
  v_pk_mul_f32 v[66:67], v[50:51], s[38:39]
  v_pk_mul_f32 v[68:69], v[52:53], s[38:39]
  v_pk_mul_f32 v[70:71], v[54:55], s[38:39]
  v_exp_f32 v64, v64
  v_exp_f32 v65, v65
  v_exp_f32 v66, v66
  v_exp_f32 v67, v67
  v_exp_f32 v68, v68
  v_exp_f32 v69, v69
  v_exp_f32 v70, v70
  v_exp_f32 v71, v71
  v_pk_mul_f32 v[48:49], v[48:49], v[56:57]
  v_pk_mul_f32 v[50:51], v[50:51], v[58:59]
  v_pk_mul_f32 v[52:53], v[52:53], v[60:61]
  v_pk_mul_f32 v[54:55], v[54:55], v[62:63]
  v_pk_add_f32 v[64:65], v[64:65], 1.0 op_sel_hi:[1,0]
  v_pk_add_f32 v[66:67], v[66:67], 1.0 op_sel_hi:[1,0]
  v_pk_add_f32 v[68:69], v[68:69], 1.0 op_sel_hi:[1,0]
  v_pk_add_f32 v[70:71], v[70:71], 1.0 op_sel_hi:[1,0]
  v_rcp_f32 v64, v64
  v_rcp_f32 v65, v65
  v_rcp_f32 v66, v66
  v_rcp_f32 v67, v67
  v_rcp_f32 v68, v68
  v_rcp_f32 v69, v69
  v_rcp_f32 v70, v70
  v_rcp_f32 v71, v71
  v_pk_mul_f32 v[48:49], v[48:49], v[64:65]
  v_pk_mul_f32 v[50:51], v[50:51], v[66:67]
  v_pk_mul_f32 v[52:53], v[52:53], v[68:69]
  v_pk_mul_f32 v[54:55], v[54:55], v[70:71]
  v_cvt_pk_bf16_f32 v72, v48, v49
  v_cvt_pk_bf16_f32 v73, v50, v51
  v_cvt_pk_bf16_f32 v74, v52, v53
  v_cvt_pk_bf16_f32 v75, v54, v55
  buffer_store_dwordx4 v[72:75], v1, s[28:31], s37 offen offset:2048 sc1
F_HDONE:
  s_waitcnt vmcnt(0)
  s_setprio 1
  s_barrier
  s_cmp_lg_u32 s32, 0
  s_cbranch_scc1 F_NOPOLL
  s_lshl_b32 s36, s41, 3
  s_add_u32 s36, s36, s40
  s_lshl_b32 s36, s36, 7
  s_add_u32 s36, s36, 0xf03000
  v_lshlrev_b32 v5, 2, v0
  v_add_u32 v5, s36, v5
  s_lshl_b32 s37, s42, 2
  s_add_u32 s36, s36, s37
  v_mov_b32 v6, s36
  v_mov_b32 v7, s80
  s_mov_b64 exec, 1
  global_store_dword v6, v7, s[14:15] sc1
  s_mov_b64 exec, -1
  s_mov_b32 s39, 65536
  s_mov_b64 exec, 0xffff
FW27:
  global_load_dword v6, v5, s[14:15] sc1
FW27_C:
  s_waitcnt vmcnt(0)
  v_cmp_ne_u32 vcc, s80, v6
  s_nop 4
  s_cbranch_vccz FW27_OK
  s_sleep 1
  s_sub_u32 s39, s39, 1
  s_cmp_lg_u32 s39, 0
  s_cbranch_scc1 FW27
FW27_OK:
  s_mov_b64 exec, -1
F_NOPOLL:
  s_barrier
  s_add_u32 s36, s55, 0
  s_mov_b32 m0, s36
  s_nop 0
  buffer_load_dwordx4 v1, s[28:31], s54 offen sc1 lds
  s_add_u32 s54, s54, 4096
  s_add_u32 s36, s55, 16384
  s_mov_b32 m0, s36
  s_nop 0
  buffer_load_dwordx4 v1, s[28:31], s54 offen sc1 lds
  s_add_u32 s54, s54, 4096
  s_add_u32 s36, s55, 32768
  s_mov_b32 m0, s36
  s_nop 0
  buffer_load_dwordx4 v1, s[28:31], s54 offen sc1 lds
  s_add_u32 s54, s54, 4096
  v_lshrrev_b32 v5, 1, v11
  v_lshl_add_u32 v5, v8, 1, v5
  s_and_b32 s36, s32, 1
  s_lshl_b32 s36, s36, 2
  v_add_u32 v5, s36, v5
  v_lshrrev_b32 v6, 1, v10
  v_lshlrev_b32 v6, 2, v6
  v_xor_b32 v5, v5, v6
  v_lshlrev_b32 v5, 4, v5
  v_and_b32 v6, 1, v11
  v_lshl_add_u32 v5, v6, 3, v5
  v_lshl_add_u32 v6, v9, 2, v10
  v_lshl_add_u32 v14, v6, 7, v5
  s_lshr_b32 s36, s32, 2
  s_lshl_b32 s37, s36, 12
  v_add_u32 v12, s37, v14
  s_lshl_b32 s37, s36, 11
  s_bfe_u32 s38, s32, 0x10001
  s_lshl_b32 s38, s38, 12
  s_add_u32 s37, s37, s38
  s_add_u32 s37, s37, 8192
  v_add_u32 v13, s37, v1
  v_mov_b32 v16, 0
  v_mov_b32 v17, 0
  v_mov_b32 v18, 0
  v_mov_b32 v19, 0
  v_mov_b32 v20, 0
  v_mov_b32 v21, 0
  v_mov_b32 v22, 0
  v_mov_b32 v23, 0
  v_mov_b32 v24, 0
  v_mov_b32 v25, 0
  v_mov_b32 v26, 0
  v_mov_b32 v27, 0
  v_mov_b32 v28, 0
  v_mov_b32 v29, 0
  v_mov_b32 v30, 0
  v_mov_b32 v31, 0
  s_waitcnt vmcnt(2)
  s_barrier
  s_add_u32 s36, s53, 49152
  s_mov_b32 m0, s36
  s_nop 0
  buffer_load_dwordx4 v2, s[24:27], s52 offen lds
  s_add_u32 s52, s52, 65536
  s_add_u32 s36, s55, 49152
  s_mov_b32 m0, s36
  s_nop 0
  buffer_load_dwordx4 v1, s[28:31], s54 offen sc1 lds
  s_add_u32 s54, s54, 4096
  ds_read_b64_tr_b16 v[48:49], v12 offset:0
  ds_read_b64_tr_b16 v[50:51], v12 offset:1024
  ds_read_b128 v[52:55], v13 offset:0
  ds_read_b64_tr_b16 v[56:57], v12 offset:2048
  ds_read_b64_tr_b16 v[58:59], v12 offset:3072
  ds_read_b128 v[60:63], v13 offset:1024
  s_waitcnt lgkmcnt(3)
  v_mfma_f32_32x32x16_bf16 v[16:31], v[48:51], v[52:55], v[16:31]
  s_waitcnt lgkmcnt(0)
  v_mfma_f32_32x32x16_bf16 v[16:31], v[56:59], v[60:63], v[16:31]
  s_waitcnt vmcnt(3)
  s_barrier
  s_add_u32 s36, s53, 0
  s_mov_b32 m0, s36
  s_nop 0
  buffer_load_dwordx4 v2, s[24:27], s52 offen lds
  s_add_u32 s52, s52, 65536
  s_add_u32 s36, s55, 0
  s_mov_b32 m0, s36
  s_nop 0
  buffer_load_dwordx4 v1, s[28:31], s54 offen sc1 lds
  s_add_u32 s54, s54, 4096
  ds_read_b64_tr_b16 v[48:49], v12 offset:16384
  ds_read_b64_tr_b16 v[50:51], v12 offset:17408
  ds_read_b128 v[52:55], v13 offset:16384
  ds_read_b64_tr_b16 v[56:57], v12 offset:18432
  ds_read_b64_tr_b16 v[58:59], v12 offset:19456
  ds_read_b128 v[60:63], v13 offset:17408
  s_waitcnt lgkmcnt(3)
  v_mfma_f32_32x32x16_bf16 v[16:31], v[48:51], v[52:55], v[16:31]
  s_waitcnt lgkmcnt(0)
  v_mfma_f32_32x32x16_bf16 v[16:31], v[56:59], v[60:63], v[16:31]
  s_waitcnt vmcnt(4)
  s_barrier
  s_add_u32 s36, s53, 16384
  s_mov_b32 m0, s36
  s_nop 0
  buffer_load_dwordx4 v2, s[24:27], s52 offen lds
  s_add_u32 s52, s52, 65536
  s_add_u32 s36, s55, 16384
  s_mov_b32 m0, s36
  s_nop 0
  buffer_load_dwordx4 v1, s[28:31], s54 offen sc1 lds
  s_add_u32 s54, s54, 4096
  ds_read_b64_tr_b16 v[48:49], v12 offset:32768
  ds_read_b64_tr_b16 v[50:51], v12 offset:33792
  ds_read_b128 v[52:55], v13 offset:32768
  ds_read_b64_tr_b16 v[56:57], v12 offset:34816
  ds_read_b64_tr_b16 v[58:59], v12 offset:35840
  ds_read_b128 v[60:63], v13 offset:33792
  s_waitcnt lgkmcnt(3)
  v_mfma_f32_32x32x16_bf16 v[16:31], v[48:51], v[52:55], v[16:31]
  s_waitcnt lgkmcnt(0)
  v_mfma_f32_32x32x16_bf16 v[16:31], v[56:59], v[60:63], v[16:31]
  s_waitcnt vmcnt(4)
  s_barrier
  s_add_u32 s36, s53, 32768
  s_mov_b32 m0, s36
  s_nop 0
  buffer_load_dwordx4 v2, s[24:27], s52 offen lds
  s_add_u32 s52, s52, 65536
  s_add_u32 s36, s55, 32768
  s_mov_b32 m0, s36
  s_nop 0
  buffer_load_dwordx4 v1, s[28:31], s54 offen sc1 lds
  s_add_u32 s54, s54, 4096
  ds_read_b64_tr_b16 v[48:49], v12 offset:49152
  ds_read_b64_tr_b16 v[50:51], v12 offset:50176
  ds_read_b128 v[52:55], v13 offset:49152
  ds_read_b64_tr_b16 v[56:57], v12 offset:51200
  ds_read_b64_tr_b16 v[58:59], v12 offset:52224
  ds_read_b128 v[60:63], v13 offset:50176
  s_waitcnt lgkmcnt(3)
  v_mfma_f32_32x32x16_bf16 v[16:31], v[48:51], v[52:55], v[16:31]
  s_waitcnt lgkmcnt(0)
  v_mfma_f32_32x32x16_bf16 v[16:31], v[56:59], v[60:63], v[16:31]
  s_waitcnt vmcnt(4)
  s_barrier
  s_add_u32 s36, s53, 49152
  s_mov_b32 m0, s36
  s_nop 0
  buffer_load_dwordx4 v2, s[24:27], s52 offen lds
  s_add_u32 s52, s52, 65536
  s_add_u32 s36, s55, 49152
  s_mov_b32 m0, s36
  s_nop 0
  buffer_load_dwordx4 v1, s[28:31], s54 offen sc1 lds
  s_add_u32 s54, s54, 4096
  ds_read_b64_tr_b16 v[48:49], v12 offset:0
  ds_read_b64_tr_b16 v[50:51], v12 offset:1024
  ds_read_b128 v[52:55], v13 offset:0
  ds_read_b64_tr_b16 v[56:57], v12 offset:2048
  ds_read_b64_tr_b16 v[58:59], v12 offset:3072
  ds_read_b128 v[60:63], v13 offset:1024
  s_waitcnt lgkmcnt(3)
  v_mfma_f32_32x32x16_bf16 v[16:31], v[48:51], v[52:55], v[16:31]
  s_waitcnt lgkmcnt(0)
  v_mfma_f32_32x32x16_bf16 v[16:31], v[56:59], v[60:63], v[16:31]
  s_waitcnt vmcnt(4)
  s_barrier
  s_add_u32 s36, s53, 0
  s_mov_b32 m0, s36
  s_nop 0
  buffer_load_dwordx4 v2, s[24:27], s52 offen lds
  s_add_u32 s52, s52, 65536
  s_add_u32 s36, s55, 0
  s_mov_b32 m0, s36
  s_nop 0
  buffer_load_dwordx4 v1, s[28:31], s54 offen sc1 lds
  s_add_u32 s54, s54, 4096
  ds_read_b64_tr_b16 v[48:49], v12 offset:16384
  ds_read_b64_tr_b16 v[50:51], v12 offset:17408
  ds_read_b128 v[52:55], v13 offset:16384
  ds_read_b64_tr_b16 v[56:57], v12 offset:18432
  ds_read_b64_tr_b16 v[58:59], v12 offset:19456
  ds_read_b128 v[60:63], v13 offset:17408
  s_waitcnt lgkmcnt(3)
  v_mfma_f32_32x32x16_bf16 v[16:31], v[48:51], v[52:55], v[16:31]
  s_waitcnt lgkmcnt(0)
  v_mfma_f32_32x32x16_bf16 v[16:31], v[56:59], v[60:63], v[16:31]
  s_waitcnt vmcnt(4)
  s_barrier
  s_add_u32 s36, s53, 16384
  s_mov_b32 m0, s36
  s_nop 0
  buffer_load_dwordx4 v2, s[24:27], s52 offen lds
  s_add_u32 s52, s52, 65536
  s_add_u32 s36, s55, 16384
  s_mov_b32 m0, s36
  s_nop 0
  buffer_load_dwordx4 v1, s[28:31], s54 offen sc1 lds
  s_add_u32 s54, s54, 4096
  ds_read_b64_tr_b16 v[48:49], v12 offset:32768
  ds_read_b64_tr_b16 v[50:51], v12 offset:33792
  ds_read_b128 v[52:55], v13 offset:32768
  ds_read_b64_tr_b16 v[56:57], v12 offset:34816
  ds_read_b64_tr_b16 v[58:59], v12 offset:35840
  ds_read_b128 v[60:63], v13 offset:33792
  s_waitcnt lgkmcnt(3)
  v_mfma_f32_32x32x16_bf16 v[16:31], v[48:51], v[52:55], v[16:31]
  s_waitcnt lgkmcnt(0)
  v_mfma_f32_32x32x16_bf16 v[16:31], v[56:59], v[60:63], v[16:31]
  s_waitcnt vmcnt(4)
  s_barrier
  s_add_u32 s36, s53, 32768
  s_mov_b32 m0, s36
  s_nop 0
  buffer_load_dwordx4 v2, s[24:27], s52 offen lds
  s_add_u32 s52, s52, 65536
  s_add_u32 s36, s55, 32768
  s_mov_b32 m0, s36
  s_nop 0
  buffer_load_dwordx4 v1, s[28:31], s54 offen sc1 lds
  s_add_u32 s54, s54, 4096
  ds_read_b64_tr_b16 v[48:49], v12 offset:49152
  ds_read_b64_tr_b16 v[50:51], v12 offset:50176
  ds_read_b128 v[52:55], v13 offset:49152
  ds_read_b64_tr_b16 v[56:57], v12 offset:51200
  ds_read_b64_tr_b16 v[58:59], v12 offset:52224
  ds_read_b128 v[60:63], v13 offset:50176
  s_waitcnt lgkmcnt(3)
  v_mfma_f32_32x32x16_bf16 v[16:31], v[48:51], v[52:55], v[16:31]
  s_waitcnt lgkmcnt(0)
  v_mfma_f32_32x32x16_bf16 v[16:31], v[56:59], v[60:63], v[16:31]
  s_waitcnt vmcnt(4)
  s_barrier
  s_add_u32 s36, s53, 49152
  s_mov_b32 m0, s36
  s_nop 0
  buffer_load_dwordx4 v2, s[24:27], s52 offen lds
  s_add_u32 s52, s52, 65536
  s_add_u32 s36, s55, 49152
  s_mov_b32 m0, s36
  s_nop 0
  buffer_load_dwordx4 v1, s[28:31], s54 offen sc1 lds
  s_add_u32 s54, s54, 4096
  ds_read_b64_tr_b16 v[48:49], v12 offset:0
  ds_read_b64_tr_b16 v[50:51], v12 offset:1024
  ds_read_b128 v[52:55], v13 offset:0
  ds_read_b64_tr_b16 v[56:57], v12 offset:2048
  ds_read_b64_tr_b16 v[58:59], v12 offset:3072
  ds_read_b128 v[60:63], v13 offset:1024
  s_waitcnt lgkmcnt(3)
  v_mfma_f32_32x32x16_bf16 v[16:31], v[48:51], v[52:55], v[16:31]
  s_waitcnt lgkmcnt(0)
  v_mfma_f32_32x32x16_bf16 v[16:31], v[56:59], v[60:63], v[16:31]
  s_waitcnt vmcnt(4)
  s_barrier
  s_add_u32 s36, s53, 0
  s_mov_b32 m0, s36
  s_nop 0
  buffer_load_dwordx4 v2, s[24:27], s52 offen lds
  s_add_u32 s52, s52, 65536
  s_add_u32 s36, s55, 0
  s_mov_b32 m0, s36
  s_nop 0
  buffer_load_dwordx4 v1, s[28:31], s54 offen sc1 lds
  s_add_u32 s54, s54, 4096
  ds_read_b64_tr_b16 v[48:49], v12 offset:16384
  ds_read_b64_tr_b16 v[50:51], v12 offset:17408
  ds_read_b128 v[52:55], v13 offset:16384
  ds_read_b64_tr_b16 v[56:57], v12 offset:18432
  ds_read_b64_tr_b16 v[58:59], v12 offset:19456
  ds_read_b128 v[60:63], v13 offset:17408
  s_waitcnt lgkmcnt(3)
  v_mfma_f32_32x32x16_bf16 v[16:31], v[48:51], v[52:55], v[16:31]
  s_waitcnt lgkmcnt(0)
  v_mfma_f32_32x32x16_bf16 v[16:31], v[56:59], v[60:63], v[16:31]
  s_waitcnt vmcnt(4)
  s_barrier
  s_add_u32 s36, s53, 16384
  s_mov_b32 m0, s36
  s_nop 0
  buffer_load_dwordx4 v2, s[24:27], s52 offen lds
  s_add_u32 s52, s52, 65536
  s_add_u32 s36, s55, 16384
  s_mov_b32 m0, s36
  s_nop 0
  buffer_load_dwordx4 v1, s[28:31], s54 offen sc1 lds
  s_add_u32 s54, s54, 4096
  ds_read_b64_tr_b16 v[48:49], v12 offset:32768
  ds_read_b64_tr_b16 v[50:51], v12 offset:33792
  ds_read_b128 v[52:55], v13 offset:32768
  ds_read_b64_tr_b16 v[56:57], v12 offset:34816
  ds_read_b64_tr_b16 v[58:59], v12 offset:35840
  ds_read_b128 v[60:63], v13 offset:33792
  s_waitcnt lgkmcnt(3)
  v_mfma_f32_32x32x16_bf16 v[16:31], v[48:51], v[52:55], v[16:31]
  s_waitcnt lgkmcnt(0)
  v_mfma_f32_32x32x16_bf16 v[16:31], v[56:59], v[60:63], v[16:31]
  s_waitcnt vmcnt(4)
  s_barrier
  s_add_u32 s36, s53, 32768
  s_mov_b32 m0, s36
  s_nop 0
  buffer_load_dwordx4 v2, s[24:27], s52 offen lds
  s_add_u32 s52, s52, 65536
  s_add_u32 s36, s55, 32768
  s_mov_b32 m0, s36
  s_nop 0
  buffer_load_dwordx4 v1, s[28:31], s54 offen sc1 lds
  s_add_u32 s54, s54, 4096
  ds_read_b64_tr_b16 v[48:49], v12 offset:49152
  ds_read_b64_tr_b16 v[50:51], v12 offset:50176
  ds_read_b128 v[52:55], v13 offset:49152
  ds_read_b64_tr_b16 v[56:57], v12 offset:51200
  ds_read_b64_tr_b16 v[58:59], v12 offset:52224
  ds_read_b128 v[60:63], v13 offset:50176
  s_waitcnt lgkmcnt(3)
  v_mfma_f32_32x32x16_bf16 v[16:31], v[48:51], v[52:55], v[16:31]
  s_waitcnt lgkmcnt(0)
  v_mfma_f32_32x32x16_bf16 v[16:31], v[56:59], v[60:63], v[16:31]
  s_waitcnt vmcnt(4)
  s_barrier
  s_add_u32 s36, s53, 49152
  s_mov_b32 m0, s36
  s_nop 0
  buffer_load_dwordx4 v2, s[24:27], s52 offen lds
  s_add_u32 s52, s52, 65536
  s_add_u32 s36, s55, 49152
  s_mov_b32 m0, s36
  s_nop 0
  buffer_load_dwordx4 v1, s[28:31], s54 offen sc1 lds
  s_add_u32 s54, s54, 4096
  ds_read_b64_tr_b16 v[48:49], v12 offset:0
  ds_read_b64_tr_b16 v[50:51], v12 offset:1024
  ds_read_b128 v[52:55], v13 offset:0
  ds_read_b64_tr_b16 v[56:57], v12 offset:2048
  ds_read_b64_tr_b16 v[58:59], v12 offset:3072
  ds_read_b128 v[60:63], v13 offset:1024
  s_waitcnt lgkmcnt(3)
  v_mfma_f32_32x32x16_bf16 v[16:31], v[48:51], v[52:55], v[16:31]
  s_waitcnt lgkmcnt(0)
  v_mfma_f32_32x32x16_bf16 v[16:31], v[56:59], v[60:63], v[16:31]
  s_waitcnt vmcnt(4)
  s_barrier
  s_add_u32 s36, s53, 0
  s_mov_b32 m0, s36
  s_nop 0
  buffer_load_dwordx4 v2, s[24:27], s52 offen lds
  s_add_u32 s52, s52, 65536
  s_add_u32 s36, s55, 0
  s_mov_b32 m0, s36
  s_nop 0
  buffer_load_dwordx4 v1, s[28:31], s54 offen sc1 lds
  s_add_u32 s54, s54, 4096
  ds_read_b64_tr_b16 v[48:49], v12 offset:16384
  ds_read_b64_tr_b16 v[50:51], v12 offset:17408
  ds_read_b128 v[52:55], v13 offset:16384
  ds_read_b64_tr_b16 v[56:57], v12 offset:18432
  ds_read_b64_tr_b16 v[58:59], v12 offset:19456
  ds_read_b128 v[60:63], v13 offset:17408
  s_waitcnt lgkmcnt(3)
  v_mfma_f32_32x32x16_bf16 v[16:31], v[48:51], v[52:55], v[16:31]
  s_waitcnt lgkmcnt(0)
  v_mfma_f32_32x32x16_bf16 v[16:31], v[56:59], v[60:63], v[16:31]
  s_waitcnt vmcnt(4)
  s_barrier
  s_add_u32 s36, s53, 16384
  s_mov_b32 m0, s36
  s_nop 0
  buffer_load_dwordx4 v2, s[24:27], s52 offen lds
  s_add_u32 s52, s52, 65536
  s_add_u32 s36, s55, 16384
  s_mov_b32 m0, s36
  s_nop 0
  buffer_load_dwordx4 v1, s[28:31], s54 offen sc1 lds
  s_add_u32 s54, s54, 4096
  ds_read_b64_tr_b16 v[48:49], v12 offset:32768
  ds_read_b64_tr_b16 v[50:51], v12 offset:33792
  ds_read_b128 v[52:55], v13 offset:32768
  ds_read_b64_tr_b16 v[56:57], v12 offset:34816
  ds_read_b64_tr_b16 v[58:59], v12 offset:35840
  ds_read_b128 v[60:63], v13 offset:33792
  s_waitcnt lgkmcnt(3)
  v_mfma_f32_32x32x16_bf16 v[16:31], v[48:51], v[52:55], v[16:31]
  s_waitcnt lgkmcnt(0)
  v_mfma_f32_32x32x16_bf16 v[16:31], v[56:59], v[60:63], v[16:31]
  s_waitcnt vmcnt(4)
  s_barrier
  s_add_u32 s36, s53, 32768
  s_mov_b32 m0, s36
  s_nop 0
  buffer_load_dwordx4 v2, s[24:27], s52 offen lds
  s_add_u32 s52, s52, 65536
  s_add_u32 s36, s55, 32768
  s_mov_b32 m0, s36
  s_nop 0
  buffer_load_dwordx4 v1, s[28:31], s54 offen sc1 lds
  s_add_u32 s54, s54, 4096
  ds_read_b64_tr_b16 v[48:49], v12 offset:49152
  ds_read_b64_tr_b16 v[50:51], v12 offset:50176
  ds_read_b128 v[52:55], v13 offset:49152
  ds_read_b64_tr_b16 v[56:57], v12 offset:51200
  ds_read_b64_tr_b16 v[58:59], v12 offset:52224
  ds_read_b128 v[60:63], v13 offset:50176
  s_waitcnt lgkmcnt(3)
  v_mfma_f32_32x32x16_bf16 v[16:31], v[48:51], v[52:55], v[16:31]
  s_waitcnt lgkmcnt(0)
  v_mfma_f32_32x32x16_bf16 v[16:31], v[56:59], v[60:63], v[16:31]
  s_waitcnt vmcnt(4)
  s_barrier
  s_add_u32 s36, s53, 49152
  s_mov_b32 m0, s36
  s_nop 0
  buffer_load_dwordx4 v2, s[24:27], s52 offen lds
  s_add_u32 s52, s52, 65536
  s_add_u32 s36, s55, 49152
  s_mov_b32 m0, s36
  s_nop 0
  buffer_load_dwordx4 v1, s[28:31], s54 offen sc1 lds
  s_add_u32 s54, s54, 4096
  ds_read_b64_tr_b16 v[48:49], v12 offset:0
  ds_read_b64_tr_b16 v[50:51], v12 offset:1024
  ds_read_b128 v[52:55], v13 offset:0
  ds_read_b64_tr_b16 v[56:57], v12 offset:2048
  ds_read_b64_tr_b16 v[58:59], v12 offset:3072
  ds_read_b128 v[60:63], v13 offset:1024
  s_waitcnt lgkmcnt(3)
  v_mfma_f32_32x32x16_bf16 v[16:31], v[48:51], v[52:55], v[16:31]
  s_waitcnt lgkmcnt(0)
  v_mfma_f32_32x32x16_bf16 v[16:31], v[56:59], v[60:63], v[16:31]
  s_waitcnt vmcnt(4)
  s_barrier
  s_add_u32 s36, s53, 0
  s_mov_b32 m0, s36
  s_nop 0
  buffer_load_dwordx4 v2, s[24:27], s52 offen lds
  s_add_u32 s52, s52, 65536
  s_add_u32 s36, s55, 0
  s_mov_b32 m0, s36
  s_nop 0
  buffer_load_dwordx4 v1, s[28:31], s54 offen sc1 lds
  s_add_u32 s54, s54, 4096
  ds_read_b64_tr_b16 v[48:49], v12 offset:16384
  ds_read_b64_tr_b16 v[50:51], v12 offset:17408
  ds_read_b128 v[52:55], v13 offset:16384
  ds_read_b64_tr_b16 v[56:57], v12 offset:18432
  ds_read_b64_tr_b16 v[58:59], v12 offset:19456
  ds_read_b128 v[60:63], v13 offset:17408
  s_waitcnt lgkmcnt(3)
  v_mfma_f32_32x32x16_bf16 v[16:31], v[48:51], v[52:55], v[16:31]
  s_waitcnt lgkmcnt(0)
  v_mfma_f32_32x32x16_bf16 v[16:31], v[56:59], v[60:63], v[16:31]
  s_waitcnt vmcnt(4)
  s_barrier
  s_add_u32 s36, s53, 16384
  s_mov_b32 m0, s36
  s_nop 0
  buffer_load_dwordx4 v2, s[24:27], s52 offen lds
  s_add_u32 s52, s52, 65536
  s_add_u32 s36, s55, 16384
  s_mov_b32 m0, s36
  s_nop 0
  buffer_load_dwordx4 v1, s[28:31], s54 offen sc1 lds
  s_add_u32 s54, s54, 4096
  ds_read_b64_tr_b16 v[48:49], v12 offset:32768
  ds_read_b64_tr_b16 v[50:51], v12 offset:33792
  ds_read_b128 v[52:55], v13 offset:32768
  ds_read_b64_tr_b16 v[56:57], v12 offset:34816
  ds_read_b64_tr_b16 v[58:59], v12 offset:35840
  ds_read_b128 v[60:63], v13 offset:33792
  s_waitcnt lgkmcnt(3)
  v_mfma_f32_32x32x16_bf16 v[16:31], v[48:51], v[52:55], v[16:31]
  s_waitcnt lgkmcnt(0)
  v_mfma_f32_32x32x16_bf16 v[16:31], v[56:59], v[60:63], v[16:31]
  s_waitcnt vmcnt(4)
  s_barrier
  ds_read_b64_tr_b16 v[48:49], v12 offset:49152
  ds_read_b64_tr_b16 v[50:51], v12 offset:50176
  ds_read_b128 v[52:55], v13 offset:49152
  ds_read_b64_tr_b16 v[56:57], v12 offset:51200
  ds_read_b64_tr_b16 v[58:59], v12 offset:52224
  ds_read_b128 v[60:63], v13 offset:50176
  s_waitcnt lgkmcnt(3)
  v_mfma_f32_32x32x16_bf16 v[16:31], v[48:51], v[52:55], v[16:31]
  s_waitcnt lgkmcnt(0)
  v_mfma_f32_32x32x16_bf16 v[16:31], v[56:59], v[60:63], v[16:31]
  s_waitcnt vmcnt(2)
  s_barrier
  ds_read_b64_tr_b16 v[48:49], v12 offset:0
  ds_read_b64_tr_b16 v[50:51], v12 offset:1024
  ds_read_b128 v[52:55], v13 offset:0
  ds_read_b64_tr_b16 v[56:57], v12 offset:2048
  ds_read_b64_tr_b16 v[58:59], v12 offset:3072
  ds_read_b128 v[60:63], v13 offset:1024
  s_waitcnt lgkmcnt(3)
  v_mfma_f32_32x32x16_bf16 v[16:31], v[48:51], v[52:55], v[16:31]
  s_waitcnt lgkmcnt(0)
  v_mfma_f32_32x32x16_bf16 v[16:31], v[56:59], v[60:63], v[16:31]
  s_waitcnt vmcnt(0)
  s_barrier
  s_cmp_ge_u32 s32, 4
  s_cbranch_scc1 F_SKIPL
  ds_read_b64_tr_b16 v[48:49], v12 offset:16384
  ds_read_b64_tr_b16 v[50:51], v12 offset:17408
  ds_read_b128 v[52:55], v13 offset:16384
  ds_read_b64_tr_b16 v[56:57], v12 offset:18432
  ds_read_b64_tr_b16 v[58:59], v12 offset:19456
  ds_read_b128 v[60:63], v13 offset:17408
  s_waitcnt lgkmcnt(3)
  v_mfma_f32_32x32x16_bf16 v[16:31], v[48:51], v[52:55], v[16:31]
  s_waitcnt lgkmcnt(0)
  v_mfma_f32_32x32x16_bf16 v[16:31], v[56:59], v[60:63], v[16:31]
F_SKIPL:
  s_lshl_b32 s36, s32, 11
  s_add_u32 s36, s36, 65536
  v_add_u32 v4, s36, v1
  v_xor_b32 v5, 8192, v4
  s_cmp_lt_u32 s32, 4
  s_cbranch_scc1 F_X28_0
  s_nop 5
  ds_write_b128 v4, v[16:19]
  ds_write_b128 v4, v[20:23] offset:1024
  s_waitcnt lgkmcnt(0)
  s_barrier
  ds_read_b128 v[48:51], v5 offset:0
  ds_read_b128 v[52:55], v5 offset:1024
  s_waitcnt lgkmcnt(1)
  v_add_f32 v48, v48, v24
  v_add_f32 v49, v49, v25
  v_add_f32 v50, v50, v26
  v_add_f32 v51, v51, v27
  s_waitcnt lgkmcnt(0)
  v_add_f32 v52, v52, v28
  v_add_f32 v53, v53, v29
  v_add_f32 v54, v54, v30
  v_add_f32 v55, v55, v31
  s_branch F_X28_1
F_X28_0:
  s_nop 5
  ds_write_b128 v4, v[24:27]
  ds_write_b128 v4, v[28:31] offset:1024
  s_waitcnt lgkmcnt(0)
  s_barrier
  ds_read_b128 v[48:51], v5 offset:0
  ds_read_b128 v[52:55], v5 offset:1024
  s_waitcnt lgkmcnt(1)
  v_add_f32 v48, v48, v16
  v_add_f32 v49, v49, v17
  v_add_f32 v50, v50, v18
  v_add_f32 v51, v51, v19
  s_waitcnt lgkmcnt(0)
  v_add_f32 v52, v52, v20
  v_add_f32 v53, v53, v21
  v_add_f32 v54, v54, v22
  v_add_f32 v55, v55, v23
F_X28_1:
  s_load_dwordx2 s[68:69], s[0:1], 32
  s_load_dwordx2 s[76:77], s[0:1], 72
  s_lshl_b32 s52, s32, 16
  s_lshl_b32 s37, s49, 7
  s_add_u32 s52, s52, s37
  s_lshl_b32 s53, s32, 13
  s_waitcnt lgkmcnt(0)
  s_and_b32 s69, s69, 0xffff
  s_mov_b32 s70, 524288
  s_mov_b32 s71, 0x00020000
  s_mov_b32 m0, s53
  s_nop 0
  buffer_load_dwordx4 v2, s[68:71], s52 offen lds
  s_add_u32 s52, s52, 8192
  s_add_u32 s53, s53, 1024
  s_mov_b32 m0, s53
  s_nop 0
  buffer_load_dwordx4 v2, s[68:71], s52 offen lds
  s_add_u32 s52, s52, 8192
  s_add_u32 s53, s53, 1024
  s_mov_b32 m0, s53
  s_nop 0
  buffer_load_dwordx4 v2, s[68:71], s52 offen lds
  s_add_u32 s52, s52, 8192
  s_add_u32 s53, s53, 1024
  s_mov_b32 m0, s53
  s_nop 0
  buffer_load_dwordx4 v2, s[68:71], s52 offen lds
  s_add_u32 s52, s52, 8192
  s_add_u32 s53, s53, 1024
  s_mov_b32 m0, s53
  s_nop 0
  buffer_load_dwordx4 v2, s[68:71], s52 offen lds
  s_add_u32 s52, s52, 8192
  s_add_u32 s53, s53, 1024
  s_mov_b32 m0, s53
  s_nop 0
  buffer_load_dwordx4 v2, s[68:71], s52 offen lds
  s_add_u32 s52, s52, 8192
  s_add_u32 s53, s53, 1024
  s_mov_b32 m0, s53
  s_nop 0
  buffer_load_dwordx4 v2, s[68:71], s52 offen lds
  s_add_u32 s52, s52, 8192
  s_add_u32 s53, s53, 1024
  s_mov_b32 m0, s53
  s_nop 0
  buffer_load_dwordx4 v2, s[68:71], s52 offen lds
  s_add_u32 s52, s52, 8192
  s_add_u32 s53, s53, 1024
  s_mov_b32 s72, s4
  s_and_b32 s73, s5, 0xffff
  s_mov_b32 s74, 2097152
  s_mov_b32 s75, 0x00020000
  s_and_b32 s77, s77, 0xffff
  s_mov_b32 s78, 2097152
  s_mov_b32 s79, 0x00020000
  v_lshrrev_b32 v7, 3, v0
  v_lshlrev_b32 v7, 10, v7
  v_and_b32 v15, 7, v0
  v_lshl_add_u32 v7, v15, 4, v7
  s_lshl_b32 s56, s48, 6
  s_lshl_b32 s37, s32, 3
  s_add_u32 s56, s56, s37
  s_lshl_b32 s56, s56, 10
  s_lshl_b32 s37, s49, 7
  s_add_u32 s56, s56, s37
  buffer_load_dwordx4 v[112:115], v7, s[72:75], s56 offen
  s_mov_b32 s60, 0xbfb8aa3b
  v_mul_f32 v64, s60, v48
  v_mul_f32 v65, s60, v49
  v_mul_f32 v66, s60, v50
  v_mul_f32 v67, s60, v51
  v_mul_f32 v68, s60, v52
  v_mul_f32 v69, s60, v53
  v_mul_f32 v70, s60, v54
  v_mul_f32 v71, s60, v55
  v_exp_f32 v64, v64
  v_exp_f32 v65, v65
  v_exp_f32 v66, v66
  v_exp_f32 v67, v67
  v_exp_f32 v68, v68
  v_exp_f32 v69, v69
  v_exp_f32 v70, v70
  v_exp_f32 v71, v71
  v_add_f32 v64, 1.0, v64
  v_add_f32 v65, 1.0, v65
  v_add_f32 v66, 1.0, v66
  v_add_f32 v67, 1.0, v67
  v_add_f32 v68, 1.0, v68
  v_add_f32 v69, 1.0, v69
  v_add_f32 v70, 1.0, v70
  v_add_f32 v71, 1.0, v71
  v_rcp_f32 v64, v64
  v_rcp_f32 v65, v65
  v_rcp_f32 v66, v66
  v_rcp_f32 v67, v67
  v_rcp_f32 v68, v68
  v_rcp_f32 v69, v69
  v_rcp_f32 v70, v70
  v_rcp_f32 v71, v71
  v_mul_f32 v104, v48, v64
  v_mul_f32 v105, v49, v65
  v_mul_f32 v106, v50, v66
  v_mul_f32 v107, v51, v67
  v_mul_f32 v108, v52, v68
  v_mul_f32 v109, v53, v69
  v_mul_f32 v110, v54, v70
  v_mul_f32 v111, v55, v71
  s_lshr_b32 s36, s32, 2
  s_lshl_b32 s37, s36, 15
  v_add_u32 v12, s37, v14
  s_bfe_u32 s38, s32, 0x10001
  s_lshl_b32 s37, s38, 15
  s_lshl_b32 s38, s36, 14
  s_add_u32 s37, s37, s38
  v_add_u32 v13, s37, v1
  s_waitcnt vmcnt(1)
  s_barrier
  ds_read_b64_tr_b16 v[16:17], v12 offset:0
  ds_read_b64_tr_b16 v[18:19], v12 offset:1024
  ds_read_b64_tr_b16 v[20:21], v12 offset:2048
  ds_read_b64_tr_b16 v[22:23], v12 offset:3072
  ds_read_b64_tr_b16 v[24:25], v12 offset:4096
  ds_read_b64_tr_b16 v[26:27], v12 offset:5120
  ds_read_b64_tr_b16 v[28:29], v12 offset:6144
  ds_read_b64_tr_b16 v[30:31], v12 offset:7168
  ds_read_b64_tr_b16 v[32:33], v12 offset:8192
  ds_read_b64_tr_b16 v[34:35], v12 offset:9216
  ds_read_b64_tr_b16 v[36:37], v12 offset:10240
  ds_read_b64_tr_b16 v[38:39], v12 offset:11264
  ds_read_b64_tr_b16 v[40:41], v12 offset:12288
  ds_read_b64_tr_b16 v[42:43], v12 offset:13312
  ds_read_b64_tr_b16 v[44:45], v12 offset:14336
  ds_read_b64_tr_b16 v[46:47], v12 offset:15360
  ds_read_b64_tr_b16 v[48:49], v12 offset:16384
  ds_read_b64_tr_b16 v[50:51], v12 offset:17408
  ds_read_b64_tr_b16 v[52:53], v12 offset:18432
  ds_read_b64_tr_b16 v[54:55], v12 offset:19456
  ds_read_b64_tr_b16 v[56:57], v12 offset:20480
  ds_read_b64_tr_b16 v[58:59], v12 offset:21504
  ds_read_b64_tr_b16 v[60:61], v12 offset:22528
  ds_read_b64_tr_b16 v[62:63], v12 offset:23552
  ds_read_b64_tr_b16 v[64:65], v12 offset:24576
  ds_read_b64_tr_b16 v[66:67], v12 offset:25600
  ds_read_b64_tr_b16 v[68:69], v12 offset:26624
  ds_read_b64_tr_b16 v[70:71], v12 offset:27648
  ds_read_b64_tr_b16 v[72:73], v12 offset:28672
  ds_read_b64_tr_b16 v[74:75], v12 offset:29696
  ds_read_b64_tr_b16 v[76:77], v12 offset:30720
  ds_read_b64_tr_b16 v[78:79], v12 offset:31744
  s_waitcnt lgkmcnt(0)
  s_barrier
  s_cmp_lg_u32 s32, 0
  s_cbranch_scc1 F_NOPOLL2
  s_lshl_b32 s36, s48, 7
  s_add_u32 s36, s36, 0xf04000
  v_lshlrev_b32 v6, 2, v0
  v_add_u32 v6, s36, v6
  s_mov_b32 s39, 65536
  s_mov_b64 exec, 0xff
FW29:
  global_load_dword v8, v6, s[14:15] sc1
FW29_C:
  s_waitcnt vmcnt(0)
  v_cmp_ne_u32 vcc, s80, v8
  s_nop 4
  s_cbranch_vccz FW29_OK
  s_sleep 1
  s_sub_u32 s39, s39, 1
  s_cmp_lg_u32 s39, 0
  s_cbranch_scc1 FW29
FW29_OK:
  s_mov_b64 exec, -1
F_NOPOLL2:
  s_barrier
  s_and_b32 s36, s32, 3
  s_lshl_b32 s37, s36, 2
  s_lshr_b32 s36, s36, 1
  s_lshl_b32 s36, s36, 3
  s_add_u32 s36, s36, s37
  s_lshr_b32 s37, s32, 2
  s_lshl_b32 s37, s37, 5
  s_add_u32 s36, s36, s37
  s_lshl_b32 s53, s36, 10
  s_lshl_b32 s52, s48, 16
  s_add_u32 s52, s52, s53
  s_add_u32 s52, s52, 0xb00000
  s_mov_b32 m0, s53
  s_nop 0
  buffer_load_dwordx4 v1, s[28:31], s52 offen sc1 lds
  s_add_u32 s52, s52, 1024
  s_add_u32 s53, s53, 1024
  s_mov_b32 m0, s53
  s_nop 0
  buffer_load_dwordx4 v1, s[28:31], s52 offen sc1 lds
  s_add_u32 s52, s52, 1024
  s_add_u32 s53, s53, 1024
  s_mov_b32 m0, s53
  s_nop 0
  buffer_load_dwordx4 v1, s[28:31], s52 offen sc1 lds
  s_add_u32 s52, s52, 1024
  s_add_u32 s53, s53, 1024
  s_mov_b32 m0, s53
  s_nop 0
  buffer_load_dwordx4 v1, s[28:31], s52 offen sc1 lds
  s_add_u32 s52, s52, 5120
  s_add_u32 s53, s53, 5120
  s_mov_b32 m0, s53
  s_nop 0
  buffer_load_dwordx4 v1, s[28:31], s52 offen sc1 lds
  s_add_u32 s52, s52, 1024
  s_add_u32 s53, s53, 1024
  s_mov_b32 m0, s53
  s_nop 0
  buffer_load_dwordx4 v1, s[28:31], s52 offen sc1 lds
  s_add_u32 s52, s52, 1024
  s_add_u32 s53, s53, 1024
  s_mov_b32 m0, s53
  s_nop 0
  buffer_load_dwordx4 v1, s[28:31], s52 offen sc1 lds
  s_add_u32 s52, s52, 1024
  s_add_u32 s53, s53, 1024
  s_mov_b32 m0, s53
  s_nop 0
  buffer_load_dwordx4 v1, s[28:31], s52 offen sc1 lds
  s_add_u32 s52, s52, 1024
  s_add_u32 s53, s53, 1024
  s_waitcnt vmcnt(4)
  s_barrier
  ds_read_b128 v[96:99], v13 offset:0
  ds_read_b128 v[100:103], v13 offset:1024
  ds_read_b128 v[116:119], v13 offset:2048
  ds_read_b128 v[120:123], v13 offset:3072
  ds_read_b128 v[124:127], v13 offset:4096
  s_waitcnt lgkmcnt(4)
  v_mfma_f32_32x32x16_bf16 v[80:95], v[16:19], v[96:99], 0
  ds_read_b128 v[96:99], v13 offset:5120
  s_waitcnt lgkmcnt(4)
  v_mfma_f32_32x32x16_bf16 v[80:95], v[20:23], v[100:103], v[80:95]
  ds_read_b128 v[100:103], v13 offset:6144
  s_waitcnt lgkmcnt(4)
  v_mfma_f32_32x32x16_bf16 v[80:95], v[24:27], v[116:119], v[80:95]
  ds_read_b128 v[116:119], v13 offset:7168
  s_waitcnt lgkmcnt(4)
  v_mfma_f32_32x32x16_bf16 v[80:95], v[28:31], v[120:123], v[80:95]
  s_waitcnt lgkmcnt(3)
  v_mfma_f32_32x32x16_bf16 v[80:95], v[32:35], v[124:127], v[80:95]
  s_waitcnt lgkmcnt(2)
  v_mfma_f32_32x32x16_bf16 v[80:95], v[36:39], v[96:99], v[80:95]
  s_waitcnt lgkmcnt(1)
  v_mfma_f32_32x32x16_bf16 v[80:95], v[40:43], v[100:103], v[80:95]
  s_waitcnt lgkmcnt(0)
  v_mfma_f32_32x32x16_bf16 v[80:95], v[44:47], v[116:119], v[80:95]
  s_waitcnt vmcnt(0)
  s_barrier
  ds_read_b128 v[120:123], v13 offset:8192
  ds_read_b128 v[124:127], v13 offset:9216
  ds_read_b128 v[96:99], v13 offset:10240
  ds_read_b128 v[100:103], v13 offset:11264
  ds_read_b128 v[116:119], v13 offset:12288
  s_waitcnt lgkmcnt(4)
  v_mfma_f32_32x32x16_bf16 v[80:95], v[48:51], v[120:123], v[80:95]
  ds_read_b128 v[120:123], v13 offset:13312
  s_waitcnt lgkmcnt(4)
  v_mfma_f32_32x32x16_bf16 v[80:95], v[52:55], v[124:127], v[80:95]
  ds_read_b128 v[124:127], v13 offset:14336
  s_waitcnt lgkmcnt(4)
  v_mfma_f32_32x32x16_bf16 v[80:95], v[56:59], v[96:99], v[80:95]
  ds_read_b128 v[96:99], v13 offset:15360
  s_waitcnt lgkmcnt(4)
  v_mfma_f32_32x32x16_bf16 v[80:95], v[60:63], v[100:103], v[80:95]
  s_waitcnt lgkmcnt(3)
  v_mfma_f32_32x32x16_bf16 v[80:95], v[64:67], v[116:119], v[80:95]
  s_waitcnt lgkmcnt(2)
  v_mfma_f32_32x32x16_bf16 v[80:95], v[68:71], v[120:123], v[80:95]
  s_waitcnt lgkmcnt(1)
  v_mfma_f32_32x32x16_bf16 v[80:95], v[72:75], v[124:127], v[80:95]
  s_waitcnt lgkmcnt(0)
  v_mfma_f32_32x32x16_bf16 v[80:95], v[76:79], v[96:99], v[80:95]
  s_cmp_lt_u32 s32, 4
  s_cbranch_scc1 F_X30_0
  s_nop 9
  ds_write_b128 v4, v[80:83]
  ds_write_b128 v4, v[84:87] offset:1024
  s_waitcnt lgkmcnt(0)
  s_barrier
  ds_read_b128 v[48:51], v5 offset:0
  ds_read_b128 v[52:55], v5 offset:1024
  s_waitcnt lgkmcnt(1)
  v_add_f32 v48, v48, v88
  v_add_f32 v49, v49, v89
  v_add_f32 v50, v50, v90
  v_add_f32 v51, v51, v91
  s_waitcnt lgkmcnt(0)
  v_add_f32 v52, v52, v92
  v_add_f32 v53, v53, v93
  v_add_f32 v54, v54, v94
  v_add_f32 v55, v55, v95
  s_branch F_X30_1
F_X30_0:
  s_nop 9
  ds_write_b128 v4, v[88:91]
  ds_write_b128 v4, v[92:95] offset:1024
  s_waitcnt lgkmcnt(0)
  s_barrier
  ds_read_b128 v[48:51], v5 offset:0
  ds_read_b128 v[52:55], v5 offset:1024
  s_waitcnt lgkmcnt(1)
  s_nop 2
  v_add_f32 v48, v48, v80
  v_add_f32 v49, v49, v81
  v_add_f32 v50, v50, v82
  v_add_f32 v51, v51, v83
  s_waitcnt lgkmcnt(0)
  v_add_f32 v52, v52, v84
  v_add_f32 v53, v53, v85
  v_add_f32 v54, v54, v86
  v_add_f32 v55, v55, v87
F_X30_1:
  v_mul_f32 v48, v48, v104
  v_mul_f32 v49, v49, v105
  v_mul_f32 v50, v50, v106
  v_mul_f32 v51, v51, v107
  v_mul_f32 v52, v52, v108
  v_mul_f32 v53, v53, v109
  v_mul_f32 v54, v54, v110
  v_mul_f32 v55, v55, v111
  v_and_b32 v2, 31, v0
  s_bfe_u32 s36, s32, 0x10001
  s_lshl_b32 s36, s36, 5
  v_add_u32 v2, s36, v2
  v_mul_u32_u24 v2, 272, v2
  s_and_b32 s36, s32, 1
  s_lshl_b32 s36, s36, 7
  s_lshr_b32 s37, s32, 2
  s_lshl_b32 s37, s37, 6
  s_add_u32 s36, s36, s37
  v_lshl_add_u32 v2, v9, 4, v2
  v_add_u32 v2, s36, v2
  ds_write_b128 v2, v[48:51]
  ds_write_b128 v2, v[52:55] offset:32
  v_lshrrev_b32 v3, 3, v0
  s_lshl_b32 s36, s32, 3
  v_add_u32 v3, s36, v3
  v_mul_u32_u24 v3, 272, v3
  v_lshl_add_u32 v3, v15, 5, v3
  s_waitcnt lgkmcnt(0)
  s_barrier
  ds_read_b128 v[48:51], v3
  ds_read_b128 v[52:55], v3 offset:16
  v_lshlrev_b32 v64, 16, v112
  v_and_b32 v65, 0xffff0000, v112
  s_waitcnt lgkmcnt(1)
  v_add_f32 v64, v64, v48
  v_add_f32 v65, v65, v49
  v_cvt_pk_bf16_f32 v112, v64, v65
  v_lshlrev_b32 v64, 16, v113
  v_and_b32 v65, 0xffff0000, v113
  v_add_f32 v64, v64, v50
  v_add_f32 v65, v65, v51
  v_cvt_pk_bf16_f32 v113, v64, v65
  v_lshlrev_b32 v64, 16, v114
  v_and_b32 v65, 0xffff0000, v114
  s_waitcnt lgkmcnt(0)
  v_add_f32 v64, v64, v52
  v_add_f32 v65, v65, v53
  v_cvt_pk_bf16_f32 v114, v64, v65
  v_lshlrev_b32 v64, 16, v115
  v_and_b32 v65, 0xffff0000, v115
  v_add_f32 v64, v64, v54
  v_add_f32 v65, v65, v55
  v_cvt_pk_bf16_f32 v115, v64, v65
  buffer_store_dwordx4 v[112:115], v7, s[76:79], s56 offen
K_END:
  s_endpgm
.section .rodata,"a"
.p2align 6
.amdhsa_kernel recurrent_scan__grouped_kv_mqa__glu_gated_swiglu__prompt_kernel
  .amdhsa_next_free_vgpr 128
  .amdhsa_next_free_sgpr 102
  .amdhsa_accum_offset 128
  .amdhsa_group_segment_fixed_size 0
  .amdhsa_kernarg_size 96
  .amdhsa_user_sgpr_count 2
  .amdhsa_user_sgpr_kernarg_segment_ptr 1
  .amdhsa_system_sgpr_workgroup_id_x 1
  .amdhsa_float_denorm_mode_32 3
.end_amdhsa_kernel
```
